```python
import torch

def _softmax(x, axis=-1):
    return torch.softmax(x, dim=axis)
def _gelu(x):
    return torch.nn.functional.gelu(x, approximate="tanh")
def _silu(x):
    return torch.nn.functional.silu(x)
def _sigmoid(x):
    return torch.sigmoid(x)
def _layernorm(x, axis=-1, eps=1e-5):
    m = x.mean(dim=axis, keepdim=True)
    v = x.var(dim=axis, keepdim=True, unbiased=False)
    return (x - m) / torch.sqrt(v + eps)
def _scatter_add(tgt, idx, src, axis=0):
    return tgt.clone().index_add_(axis, idx, src)
def _segment_sum(src, seg, n):
    out = torch.zeros((n,) + src.shape[1:], dtype=src.dtype)
    return out.index_add_(0, seg, src)
def _pad(x, pw):
    flat = tuple(v for pair in reversed(pw) for v in pair)
    return torch.nn.functional.pad(x, flat)

kernel_name = 'interleave_layers__sliding_block__mha_block__prompt'

def setup_inputs():

    _w = (lambda a: (lambda t: t.to(torch.bfloat16) if t.is_floating_point() else t)(torch.as_tensor(a)))
    def _A_setup():
        B, S, D = 1, 2048, 640
        return {
            "x": _w((lambda *s: torch.randn(*s, dtype=torch.bfloat16) * 0.05)(B, S, D)),
            "wqkv": _w((lambda *s: torch.randn(*s, dtype=torch.bfloat16) * 0.05)(D, 3 * D)),
            "wo": _w((lambda *s: torch.randn(*s, dtype=torch.bfloat16) * 0.05)(D, D)),
        }
    _A_in = _A_setup()

    def _B_setup():
        B, S, D, H = 1, 2048, 640, 32
        return {
            "x": _w((lambda *s: torch.randn(*s, dtype=torch.bfloat16) * 0.05)(B, S, D)),
            "wqkv": _w((lambda *s: torch.randn(*s, dtype=torch.bfloat16) * 0.05)(D, 3 * D)),
            "wo": _w((lambda *s: torch.randn(*s, dtype=torch.bfloat16) * 0.05)(D, D)),
        }
    _B_in = _B_setup()

    return {
        "A_x": _A_in["x"],
        "A_wqkv": _A_in["wqkv"],
        "A_wo": _A_in["wo"],
        "B_x": _B_in["x"],
        "B_wqkv": _B_in["wqkv"],
        "B_wo": _B_in["wo"],
    }

def reference(A_x, A_wqkv, A_wo, B_x, B_wqkv, B_wo):
    def _A_ref(x, wqkv, wo):
        B, S, D = x.shape
        H = 32; Dh = D // H; W = 256
        qkv = (lambda x, *d: x.permute(*d))((x @ wqkv).reshape(B, S, 3, H, Dh), 2, 0, 3, 1, 4)
        q, k, v = qkv[0], qkv[1], qkv[2]
        scores = torch.einsum("bhqd,bhkd->bhqk", q, k) * (Dh ** -0.5)
        idx = torch.arange(S)
        mask = (idx[:, None] - idx[None, :] >= 0) & (idx[:, None] - idx[None, :] < W)
        scores = torch.where(mask[None, None], scores, -1e9)
        p = _softmax(scores, axis=-1)
        o = torch.einsum("bhqk,bhkd->bhqd", p, v)
        return (lambda x, *d: x.permute(*d))(o, 0, 2, 1, 3).reshape(B, S, D) @ wo

    def _B_ref(x, wqkv, wo):
        B, S, D = x.shape
        H = 32
        Dh = D // H
        qkv = (lambda x, *d: x.permute(*d))((x @ wqkv).reshape(B, S, 3, H, Dh), 2, 0, 3, 1, 4)
        q, k, v = qkv[0], qkv[1], qkv[2]
        scores = torch.einsum("bhqd,bhkd->bhqk", q, k) * (Dh ** -0.5)
        p = _softmax(scores, axis=-1)
        o = torch.einsum("bhqk,bhkd->bhqd", p, v)
        return (lambda x, *d: x.permute(*d))(o, 0, 2, 1, 3).reshape(B, S, D) @ wo

    x = A_x
    x = x + _A_ref(_layernorm(x, axis=-1), A_wqkv, A_wo)
    x = x + _B_ref(_layernorm(x, axis=-1), B_wqkv, B_wo)
    x = x + _A_ref(_layernorm(x, axis=-1), A_wqkv, A_wo)
    x = x + _B_ref(_layernorm(x, axis=-1), B_wqkv, B_wo)
    return x
```

```asm
; @launch kernel=qkv0_kernel grid=(256,1,1) block=(512,1,1) lds=163840
; @launch kernel=fus0_kernel grid=(256,1,1) block=(576,1,1) lds=163840
; @launch kernel=fus1_kernel grid=(256,1,1) block=(576,1,1) lds=163840
; @launch kernel=fus2_kernel grid=(256,1,1) block=(576,1,1) lds=163840
; @launch kernel=fus3_kernel grid=(256,1,1) block=(576,1,1) lds=163840
.amdgcn_target "amdgcn-amd-amdhsa--gfx950"
.text
.globl qkv0_kernel
.p2align 8
.type qkv0_kernel,@function
qkv0_kernel:
    s_load_dwordx2 s[4:5], s[0:1], 0
    s_load_dwordx2 s[6:7], s[0:1], 8
    s_load_dwordx2 s[8:9], s[0:1], 64
    s_mov_b32 s10, 13238272
    s_mov_b32 s45, 0
qkvs_body:
    s_cmp_ge_u32 s2, 256
    s_cbranch_scc1 qkvs_end
    s_and_b32 s28, s2, 7
    s_lshr_b32 s29, s2, 3
    s_lshr_b32 s11, s28, 1
    s_lshl_b32 s11, s11, 2
    s_and_b32 s30, s29, 3
    s_add_u32 s11, s11, s30
    s_and_b32 s12, s28, 1
    s_lshl_b32 s12, s12, 3
    s_lshr_b32 s30, s29, 2
    s_add_u32 s12, s12, s30
    s_cmp_ge_u32 s12, 15
    s_cbranch_scc1 qkvs_aux
    v_lshrrev_b32 v1, 6, v0
    v_and_b32 v0, 63, v0
    v_readfirstlane_b32 s13, v1
    s_mul_i32 s28, s11, 163840
    s_add_u32 s28, s28, s45
    s_lshl_b32 s29, s12, 8
    s_mov_b32 s18, 163840
    s_mov_b32 s19, 0x20000
    s_sub_u32 s22, 2457600, s29
    s_mov_b32 s23, 0x20000
    s_cmp_ge_u32 s13, 4
    s_cbranch_scc0 qkvs_cons
    s_sub_u32 s13, s13, 4
    v_lshrrev_b32 v1, 3, v0
    s_lshl_b32 s30, s13, 3
    v_add_u32 v1, s30, v1
    v_lshrrev_b32 v2, 1, v1
    v_xor_b32 v2, v2, v0
    v_and_b32 v2, 7, v2
    v_mul_u32_u24 v1, 1280, v1
    v_lshl_add_u32 v1, v2, 4, v1
    v_lshrrev_b32 v3, 4, v0
    v_lshrrev_b32 v4, 2, v0
    v_xor_b32 v4, v4, v3
    v_and_b32 v4, 3, v4
    v_and_b32 v5, 3, v0
    s_lshl_b32 s30, s13, 2
    v_add_u32 v3, s30, v3
    v_mul_u32_u24 v2, 3840, v3
    v_lshl_add_u32 v2, v4, 6, v2
    v_lshl_add_u32 v2, v5, 4, v2
    s_lshl_b32 s30, s13, 10
    s_mov_b32 s31, 0
    s_mov_b32 s32, 0
    s_mov_b32 s33, 0
    s_waitcnt lgkmcnt(0)
    s_add_u32 s16, s4, s28
    s_addc_u32 s17, s5, 0
    s_add_u32 s20, s6, s29
    s_addc_u32 s21, s7, 0
qkvs_ld_loop:
    s_cmp_lt_u32 s33, 5
    s_cbranch_scc0 qkvs_ld_b
    s_cmp_eq_u32 s33, 3
    s_cbranch_scc0 qkvs_ld_issue
    s_waitcnt vmcnt(16)
    s_barrier
    s_branch qkvs_ld_issue
qkvs_ld_b:
    s_waitcnt vmcnt(24)
    s_barrier
qkvs_ld_issue:
    s_add_u32 m0, s30, 0
    s_add_u32 s34, s31, 0
    buffer_load_dwordx4 v1, s[16:19], s34 offen lds
    s_add_u32 m0, s30, 16384
    s_add_u32 s35, s32, 0
    buffer_load_dwordx4 v2, s[20:23], s35 offen lds
    s_add_u32 m0, s30, 4096
    s_add_u32 s34, s31, 40960
    buffer_load_dwordx4 v1, s[16:19], s34 offen lds
    s_add_u32 m0, s30, 20480
    s_add_u32 s35, s32, 61440
    buffer_load_dwordx4 v2, s[20:23], s35 offen lds
    s_add_u32 m0, s30, 8192
    s_add_u32 s34, s31, 81920
    buffer_load_dwordx4 v1, s[16:19], s34 offen lds
    s_add_u32 m0, s30, 24576
    s_add_u32 s35, s32, 122880
    buffer_load_dwordx4 v2, s[20:23], s35 offen lds
    s_add_u32 m0, s30, 12288
    s_add_u32 s34, s31, 122880
    buffer_load_dwordx4 v1, s[16:19], s34 offen lds
    s_add_u32 m0, s30, 28672
    s_add_u32 s35, s32, 184320
    buffer_load_dwordx4 v2, s[20:23], s35 offen lds
    s_add_u32 s30, s30, 32768
    s_add_u32 s31, s31, 128
    s_add_u32 s32, s32, 245760
    s_add_u32 s33, s33, 1
    s_cmp_eq_u32 s33, 5
    s_cselect_b32 s34, 163840, 0
    s_sub_u32 s30, s30, s34
    s_cmp_lt_u32 s33, 10
    s_cbranch_scc1 qkvs_ld_loop
    s_load_dwordx2 s[56:57], s[0:1], 16
    s_load_dwordx2 s[60:61], s[0:1], 40
    s_mul_i32 s46, s11, 15
    s_add_u32 s46, s46, s12
    s_lshl_b32 s46, s46, 8
    s_lshl_b32 s47, s13, 6
    s_add_u32 s46, s46, s47
    v_add_u32 v6, s46, v0
    v_lshlrev_b32 v3, 4, v6
    v_lshrrev_b32 v4, 8, v6
    v_mul_u32_u24 v4, 2622, v4
    v_lshrrev_b32 v4, 16, v4
    v_mul_u32_u24 v5, 6400, v4
    v_sub_u32 v5, v6, v5
    v_mul_u32_u24 v16, 6554, v5
    v_lshrrev_b32 v16, 16, v16
    v_mul_u32_u24 v17, 10, v16
    v_sub_u32 v5, v5, v17
    v_lshrrev_b32 v17, 5, v16
    v_lshrrev_b32 v18, 2, v16
    v_and_b32 v19, 3, v18
    v_lshl_add_u32 v17, v17, 2, v19
    v_lshrrev_b32 v19, 1, v17
    v_mul_u32_u24 v19, 20, v19
    v_and_b32 v17, 1, v17
    v_lshl_add_u32 v19, v17, 3, v19
    v_and_b32 v17, 4, v18
    v_add_u32 v19, v19, v17
    v_subrev_u32 v18, 128, v18
    v_mul_u32_u24 v18, 20, v18
    v_add_u32 v18, 16, v18
    s_movk_i32 s47, 512
    v_cmp_le_u32 s[48:49], s47, v16
    v_and_b32 v16, 3, v16
    s_nop 0
    v_cndmask_b32 v7, v19, v18, s[48:49]
    v_add_u32 v7, v7, v16
    v_mul_u32_u24 v7, 1280, v7
    v_mul_u32_u24 v4, 160, v4
    v_add_u32 v7, v7, v4
    v_lshl_add_u32 v7, v5, 4, v7
    s_mov_b32 s47, 51200
    v_cmp_gt_u32 s[48:49], s47, v6
    v_mov_b32 v4, 0x7fffff00
    s_nop 0
    v_cndmask_b32 v3, v4, v3, s[48:49]
    v_cndmask_b32 v7, v4, v7, s[48:49]
    s_mov_b32 s58, 819200
    s_mov_b32 s59, 0x20000
    s_mov_b32 s62, 819200
    s_mov_b32 s63, 0x20000
    s_add_u32 s24, s8, 13303808
    s_addc_u32 s25, s9, 0
    s_mov_b32 s26, 1671168
    s_mov_b32 s27, 0x20000
    s_mov_b32 s47, 851968
    s_load_dwordx2 s[40:41], s[0:1], 32
    v_mul_u32_u24 v6, 3840, v0
    s_lshl_b32 s43, s12, 8
    s_lshl_b32 s42, s11, 4
    s_add_u32 s46, s42, s43
    s_mov_b32 s42, 2457600
    s_mov_b32 s43, 0x20000
    s_waitcnt lgkmcnt(0)
    buffer_load_dwordx4 v[8:11], v7, s[56:59], 0 offen
    buffer_load_dwordx4 v[12:15], v7, s[60:63], 0 offen
    s_cmp_lg_u32 s13, 0
    s_cbranch_scc1 qkvs_ld_tail
    s_add_u32 s34, s46, 0
    buffer_load_dwordx4 v[32:35], v6, s[40:43], s34 offen
    s_add_u32 s34, s46, 245760
    buffer_load_dwordx4 v[36:39], v6, s[40:43], s34 offen
    s_add_u32 s34, s46, 491520
    buffer_load_dwordx4 v[40:43], v6, s[40:43], s34 offen
    s_add_u32 s34, s46, 737280
    buffer_load_dwordx4 v[44:47], v6, s[40:43], s34 offen
    s_add_u32 s34, s46, 983040
    buffer_load_dwordx4 v[48:51], v6, s[40:43], s34 offen
    s_add_u32 s34, s46, 1228800
    buffer_load_dwordx4 v[52:55], v6, s[40:43], s34 offen
    s_add_u32 s34, s46, 1474560
    buffer_load_dwordx4 v[56:59], v6, s[40:43], s34 offen
    s_add_u32 s34, s46, 1720320
    buffer_load_dwordx4 v[60:63], v6, s[40:43], s34 offen
    s_add_u32 s34, s46, 1966080
    buffer_load_dwordx4 v[64:67], v6, s[40:43], s34 offen
    s_add_u32 s34, s46, 2211840
    buffer_load_dwordx4 v[68:71], v6, s[40:43], s34 offen
    s_waitcnt vmcnt(36)
    s_barrier
    s_waitcnt vmcnt(28)
    s_barrier
    s_waitcnt vmcnt(20)
    s_barrier
    s_waitcnt vmcnt(12)
    s_barrier
    s_waitcnt vmcnt(10)
    buffer_store_dwordx4 v[8:11], v3, s[24:27], 0 offen sc0 sc1
    buffer_store_dwordx4 v[12:15], v3, s[24:27], s47 offen sc0 sc1
    s_barrier
    s_waitcnt vmcnt(2)
    v_lshlrev_b32 v20, 16, v32
    v_and_b32 v21, 0xffff0000, v32
    v_lshlrev_b32 v22, 16, v33
    v_and_b32 v23, 0xffff0000, v33
    v_lshlrev_b32 v24, 16, v34
    v_and_b32 v25, 0xffff0000, v34
    v_lshlrev_b32 v26, 16, v35
    v_and_b32 v27, 0xffff0000, v35
    v_lshlrev_b32 v4, 16, v36
    v_and_b32 v5, 0xffff0000, v36
    v_add_f32 v20, v20, v4
    v_add_f32 v21, v21, v5
    v_lshlrev_b32 v4, 16, v37
    v_and_b32 v5, 0xffff0000, v37
    v_add_f32 v22, v22, v4
    v_add_f32 v23, v23, v5
    v_lshlrev_b32 v4, 16, v38
    v_and_b32 v5, 0xffff0000, v38
    v_add_f32 v24, v24, v4
    v_add_f32 v25, v25, v5
    v_lshlrev_b32 v4, 16, v39
    v_and_b32 v5, 0xffff0000, v39
    v_add_f32 v26, v26, v4
    v_add_f32 v27, v27, v5
    v_lshlrev_b32 v4, 16, v40
    v_and_b32 v5, 0xffff0000, v40
    v_add_f32 v20, v20, v4
    v_add_f32 v21, v21, v5
    v_lshlrev_b32 v4, 16, v41
    v_and_b32 v5, 0xffff0000, v41
    v_add_f32 v22, v22, v4
    v_add_f32 v23, v23, v5
    v_lshlrev_b32 v4, 16, v42
    v_and_b32 v5, 0xffff0000, v42
    v_add_f32 v24, v24, v4
    v_add_f32 v25, v25, v5
    v_lshlrev_b32 v4, 16, v43
    v_and_b32 v5, 0xffff0000, v43
    v_add_f32 v26, v26, v4
    v_add_f32 v27, v27, v5
    v_lshlrev_b32 v4, 16, v44
    v_and_b32 v5, 0xffff0000, v44
    v_add_f32 v20, v20, v4
    v_add_f32 v21, v21, v5
    v_lshlrev_b32 v4, 16, v45
    v_and_b32 v5, 0xffff0000, v45
    v_add_f32 v22, v22, v4
    v_add_f32 v23, v23, v5
    v_lshlrev_b32 v4, 16, v46
    v_and_b32 v5, 0xffff0000, v46
    v_add_f32 v24, v24, v4
    v_add_f32 v25, v25, v5
    v_lshlrev_b32 v4, 16, v47
    v_and_b32 v5, 0xffff0000, v47
    v_add_f32 v26, v26, v4
    v_add_f32 v27, v27, v5
    v_lshlrev_b32 v4, 16, v48
    v_and_b32 v5, 0xffff0000, v48
    v_add_f32 v20, v20, v4
    v_add_f32 v21, v21, v5
    v_lshlrev_b32 v4, 16, v49
    v_and_b32 v5, 0xffff0000, v49
    v_add_f32 v22, v22, v4
    v_add_f32 v23, v23, v5
    v_lshlrev_b32 v4, 16, v50
    v_and_b32 v5, 0xffff0000, v50
    v_add_f32 v24, v24, v4
    v_add_f32 v25, v25, v5
    v_lshlrev_b32 v4, 16, v51
    v_and_b32 v5, 0xffff0000, v51
    v_add_f32 v26, v26, v4
    v_add_f32 v27, v27, v5
    v_lshlrev_b32 v4, 16, v52
    v_and_b32 v5, 0xffff0000, v52
    v_add_f32 v20, v20, v4
    v_add_f32 v21, v21, v5
    v_lshlrev_b32 v4, 16, v53
    v_and_b32 v5, 0xffff0000, v53
    v_add_f32 v22, v22, v4
    v_add_f32 v23, v23, v5
    v_lshlrev_b32 v4, 16, v54
    v_and_b32 v5, 0xffff0000, v54
    v_add_f32 v24, v24, v4
    v_add_f32 v25, v25, v5
    v_lshlrev_b32 v4, 16, v55
    v_and_b32 v5, 0xffff0000, v55
    v_add_f32 v26, v26, v4
    v_add_f32 v27, v27, v5
    v_lshlrev_b32 v4, 16, v56
    v_and_b32 v5, 0xffff0000, v56
    v_add_f32 v20, v20, v4
    v_add_f32 v21, v21, v5
    v_lshlrev_b32 v4, 16, v57
    v_and_b32 v5, 0xffff0000, v57
    v_add_f32 v22, v22, v4
    v_add_f32 v23, v23, v5
    v_lshlrev_b32 v4, 16, v58
    v_and_b32 v5, 0xffff0000, v58
    v_add_f32 v24, v24, v4
    v_add_f32 v25, v25, v5
    v_lshlrev_b32 v4, 16, v59
    v_and_b32 v5, 0xffff0000, v59
    v_add_f32 v26, v26, v4
    v_add_f32 v27, v27, v5
    v_lshlrev_b32 v4, 16, v60
    v_and_b32 v5, 0xffff0000, v60
    v_add_f32 v20, v20, v4
    v_add_f32 v21, v21, v5
    v_lshlrev_b32 v4, 16, v61
    v_and_b32 v5, 0xffff0000, v61
    v_add_f32 v22, v22, v4
    v_add_f32 v23, v23, v5
    v_lshlrev_b32 v4, 16, v62
    v_and_b32 v5, 0xffff0000, v62
    v_add_f32 v24, v24, v4
    v_add_f32 v25, v25, v5
    v_lshlrev_b32 v4, 16, v63
    v_and_b32 v5, 0xffff0000, v63
    v_add_f32 v26, v26, v4
    v_add_f32 v27, v27, v5
    v_lshlrev_b32 v4, 16, v64
    v_and_b32 v5, 0xffff0000, v64
    v_add_f32 v20, v20, v4
    v_add_f32 v21, v21, v5
    v_lshlrev_b32 v4, 16, v65
    v_and_b32 v5, 0xffff0000, v65
    v_add_f32 v22, v22, v4
    v_add_f32 v23, v23, v5
    v_lshlrev_b32 v4, 16, v66
    v_and_b32 v5, 0xffff0000, v66
    v_add_f32 v24, v24, v4
    v_add_f32 v25, v25, v5
    v_lshlrev_b32 v4, 16, v67
    v_and_b32 v5, 0xffff0000, v67
    v_add_f32 v26, v26, v4
    v_add_f32 v27, v27, v5
    v_lshlrev_b32 v4, 16, v68
    v_and_b32 v5, 0xffff0000, v68
    v_add_f32 v20, v20, v4
    v_add_f32 v21, v21, v5
    v_lshlrev_b32 v4, 16, v69
    v_and_b32 v5, 0xffff0000, v69
    v_add_f32 v22, v22, v4
    v_add_f32 v23, v23, v5
    v_lshlrev_b32 v4, 16, v70
    v_and_b32 v5, 0xffff0000, v70
    v_add_f32 v24, v24, v4
    v_add_f32 v25, v25, v5
    v_lshlrev_b32 v4, 16, v71
    v_and_b32 v5, 0xffff0000, v71
    v_add_f32 v26, v26, v4
    v_add_f32 v27, v27, v5
    v_add_f32_dpp v20, v20, v20 quad_perm:[1,0,3,2] row_mask:0xf bank_mask:0xf
    v_add_f32_dpp v21, v21, v21 quad_perm:[1,0,3,2] row_mask:0xf bank_mask:0xf
    v_add_f32_dpp v22, v22, v22 quad_perm:[1,0,3,2] row_mask:0xf bank_mask:0xf
    v_add_f32_dpp v23, v23, v23 quad_perm:[1,0,3,2] row_mask:0xf bank_mask:0xf
    v_add_f32_dpp v24, v24, v24 quad_perm:[1,0,3,2] row_mask:0xf bank_mask:0xf
    v_add_f32_dpp v25, v25, v25 quad_perm:[1,0,3,2] row_mask:0xf bank_mask:0xf
    v_add_f32_dpp v26, v26, v26 quad_perm:[1,0,3,2] row_mask:0xf bank_mask:0xf
    v_add_f32_dpp v27, v27, v27 quad_perm:[1,0,3,2] row_mask:0xf bank_mask:0xf
    v_add_f32_dpp v20, v20, v20 quad_perm:[2,3,0,1] row_mask:0xf bank_mask:0xf
    v_add_f32_dpp v21, v21, v21 quad_perm:[2,3,0,1] row_mask:0xf bank_mask:0xf
    v_add_f32_dpp v22, v22, v22 quad_perm:[2,3,0,1] row_mask:0xf bank_mask:0xf
    v_add_f32_dpp v23, v23, v23 quad_perm:[2,3,0,1] row_mask:0xf bank_mask:0xf
    v_add_f32_dpp v24, v24, v24 quad_perm:[2,3,0,1] row_mask:0xf bank_mask:0xf
    v_add_f32_dpp v25, v25, v25 quad_perm:[2,3,0,1] row_mask:0xf bank_mask:0xf
    v_add_f32_dpp v26, v26, v26 quad_perm:[2,3,0,1] row_mask:0xf bank_mask:0xf
    v_add_f32_dpp v27, v27, v27 quad_perm:[2,3,0,1] row_mask:0xf bank_mask:0xf
    v_add_f32_dpp v20, v20, v20 row_half_mirror row_mask:0xf bank_mask:0xf
    v_add_f32_dpp v21, v21, v21 row_half_mirror row_mask:0xf bank_mask:0xf
    v_add_f32_dpp v22, v22, v22 row_half_mirror row_mask:0xf bank_mask:0xf
    v_add_f32_dpp v23, v23, v23 row_half_mirror row_mask:0xf bank_mask:0xf
    v_add_f32_dpp v24, v24, v24 row_half_mirror row_mask:0xf bank_mask:0xf
    v_add_f32_dpp v25, v25, v25 row_half_mirror row_mask:0xf bank_mask:0xf
    v_add_f32_dpp v26, v26, v26 row_half_mirror row_mask:0xf bank_mask:0xf
    v_add_f32_dpp v27, v27, v27 row_half_mirror row_mask:0xf bank_mask:0xf
    v_add_f32_dpp v20, v20, v20 row_mirror row_mask:0xf bank_mask:0xf
    v_add_f32_dpp v21, v21, v21 row_mirror row_mask:0xf bank_mask:0xf
    v_add_f32_dpp v22, v22, v22 row_mirror row_mask:0xf bank_mask:0xf
    v_add_f32_dpp v23, v23, v23 row_mirror row_mask:0xf bank_mask:0xf
    v_add_f32_dpp v24, v24, v24 row_mirror row_mask:0xf bank_mask:0xf
    v_add_f32_dpp v25, v25, v25 row_mirror row_mask:0xf bank_mask:0xf
    v_add_f32_dpp v26, v26, v26 row_mirror row_mask:0xf bank_mask:0xf
    v_add_f32_dpp v27, v27, v27 row_mirror row_mask:0xf bank_mask:0xf
    v_mov_b32 v32, v20
    v_mov_b32 v33, v21
    v_mov_b32 v34, v22
    v_mov_b32 v35, v23
    v_mov_b32 v36, v24
    v_mov_b32 v37, v25
    v_mov_b32 v38, v26
    v_mov_b32 v39, v27
    v_permlane16_swap_b32 v32, v20
    v_permlane16_swap_b32 v33, v21
    v_permlane16_swap_b32 v34, v22
    v_permlane16_swap_b32 v35, v23
    v_permlane16_swap_b32 v36, v24
    v_permlane16_swap_b32 v37, v25
    v_permlane16_swap_b32 v38, v26
    v_permlane16_swap_b32 v39, v27
    v_add_f32 v20, v20, v32
    v_add_f32 v21, v21, v33
    v_add_f32 v22, v22, v34
    v_add_f32 v23, v23, v35
    v_add_f32 v24, v24, v36
    v_add_f32 v25, v25, v37
    v_add_f32 v26, v26, v38
    v_add_f32 v27, v27, v39
    v_mov_b32 v32, v20
    v_mov_b32 v33, v21
    v_mov_b32 v34, v22
    v_mov_b32 v35, v23
    v_mov_b32 v36, v24
    v_mov_b32 v37, v25
    v_mov_b32 v38, v26
    v_mov_b32 v39, v27
    v_permlane32_swap_b32 v32, v20
    v_permlane32_swap_b32 v33, v21
    v_permlane32_swap_b32 v34, v22
    v_permlane32_swap_b32 v35, v23
    v_permlane32_swap_b32 v36, v24
    v_permlane32_swap_b32 v37, v25
    v_permlane32_swap_b32 v38, v26
    v_permlane32_swap_b32 v39, v27
    v_add_f32 v20, v20, v32
    v_add_f32 v21, v21, v33
    v_add_f32 v22, v22, v34
    v_add_f32 v23, v23, v35
    v_add_f32 v24, v24, v36
    v_add_f32 v25, v25, v37
    v_add_f32 v26, v26, v38
    v_add_f32 v27, v27, v39
    v_cmp_eq_u32 s[48:49], 1, v0
    s_nop 1
    v_cndmask_b32 v20, v20, v21, s[48:49]
    v_cmp_eq_u32 s[48:49], 2, v0
    s_nop 1
    v_cndmask_b32 v20, v20, v22, s[48:49]
    v_cmp_eq_u32 s[48:49], 3, v0
    s_nop 1
    v_cndmask_b32 v20, v20, v23, s[48:49]
    v_cmp_eq_u32 s[48:49], 4, v0
    s_nop 1
    v_cndmask_b32 v20, v20, v24, s[48:49]
    v_cmp_eq_u32 s[48:49], 5, v0
    s_nop 1
    v_cndmask_b32 v20, v20, v25, s[48:49]
    v_cmp_eq_u32 s[48:49], 6, v0
    s_nop 1
    v_cndmask_b32 v20, v20, v26, s[48:49]
    v_cmp_eq_u32 s[48:49], 7, v0
    s_nop 1
    v_cndmask_b32 v20, v20, v27, s[48:49]
    v_cvt_pk_bf16_f32 v10, v20, v20
    v_and_b32 v10, 0xffff0000, v10
    v_sub_f32 v11, v20, v10
    v_cvt_pk_bf16_f32 v8, v10, v11
    v_and_b32 v10, 0xffff0000, v8
    v_sub_f32 v11, v11, v10
    v_mov_b32 v10, 0
    v_cvt_pk_bf16_f32 v9, v11, v10
    s_add_u32 s52, s8, 13254656
    s_addc_u32 s53, s9, 0
    s_mov_b32 s54, 15360
    s_mov_b32 s55, 0x20000
    s_lshl_b32 s29, s46, 2
    v_lshlrev_b32 v4, 3, v0
    s_mov_b64 exec, 0xff
    buffer_store_dwordx2 v[8:9], v4, s[52:55], s29 offen sc0 sc1
    s_endpgm
qkvs_ld_tail:
    s_waitcnt vmcnt(26)
    s_barrier
    s_waitcnt vmcnt(18)
    s_barrier
    s_waitcnt vmcnt(10)
    s_barrier
    s_waitcnt vmcnt(2)
    s_barrier
    s_waitcnt vmcnt(0)
    buffer_store_dwordx4 v[8:11], v3, s[24:27], 0 offen sc0 sc1
    buffer_store_dwordx4 v[12:15], v3, s[24:27], s47 offen sc0 sc1
    s_barrier
qkvs_end:
    s_endpgm
qkvs_cons:
    s_lshr_b32 s14, s13, 1
    s_and_b32 s15, s13, 1
    v_lshrrev_b32 v2, 5, v0
    v_and_b32 v3, 31, v0
    s_lshl_b32 s40, s11, 2
    s_lshl_b32 s28, s14, 1
    s_add_u32 s40, s40, s28
    s_add_u32 s40, s40, s15
    s_xor_b32 s41, s40, 1
    s_mov_b32 s50, -1
    s_mov_b32 s51, 0
    s_mov_b32 s38, 1.0
    s_cmp_lt_u32 s12, 5
    s_cmov_b32 s38, 0x3ea52b5c
    s_mov_b32 s55, 0x20000
    s_mov_b32 s54, 0x4000000
    s_cmp_lt_u32 s12, 10
    s_cselect_b64 s[62:63], -1, 0
    v_and_b32 v4, 0x13, v0
    v_and_b32 v5, 4, v0
    v_lshl_add_u32 v4, v5, 1, v4
    v_and_b32 v5, 8, v0
    v_lshrrev_b32 v5, 1, v5
    v_add_u32 v4, v4, v5
    v_cndmask_b32 v62, v3, v4, s[62:63]
    s_waitcnt lgkmcnt(0)
    s_add_u32 s52, s8, 13107200
    s_addc_u32 s53, s9, 0
    s_mov_b32 s16, s4
    s_mov_b32 s17, s5
    s_mov_b32 s18, 2621440
    s_mov_b32 s20, s6
    s_mov_b32 s21, s7
    s_mov_b32 s22, 2457600
    s_mul_i32 s28, s11, 15
    s_add_u32 s28, s28, s12
    s_lshl_b32 s28, s28, 2
    s_add_u32 s28, s28, s13
    s_mul_i32 s29, s28, 2816
    s_mul_i32 s28, s28, 2560
    v_lshlrev_b32 v4, 7, v0
    s_mov_b64 exec, 0x3fffff
    buffer_load_dword v50, v4, s[16:19], s29 offen
    s_mov_b64 exec, 0xfffff
    buffer_load_dword v52, v4, s[20:23], s28 offen
    s_mov_b64 exec, -1
    v_lshrrev_b32 v4, 1, v3
    v_xor_b32 v4, v4, v2
    v_and_b32 v4, 7, v4
    v_lshlrev_b32 v4, 4, v4
    v_lshl_add_u32 v4, v3, 7, v4
    s_lshl_b32 s28, s14, 13
    s_lshl_b32 s29, s15, 12
    s_add_u32 s30, s28, s29
    s_xor_b32 s31, s30, 4096
    v_add_u32 v8, s30, v4
    v_add_u32 v12, s31, v4
    v_xor_b32 v9, 32, v8
    v_xor_b32 v10, 64, v8
    v_xor_b32 v11, 96, v8
    v_xor_b32 v13, 32, v12
    v_xor_b32 v14, 64, v12
    v_xor_b32 v15, 96, v12
    v_lshrrev_b32 v4, 2, v0
    v_and_b32 v4, 3, v4
    v_lshl_add_u32 v5, v2, 3, v4
    v_lshlrev_b32 v5, 8, v5
    v_and_b32 v6, 16, v0
    v_lshl_add_u32 v5, v6, 1, v5
    v_and_b32 v6, 3, v0
    v_lshlrev_b32 v6, 3, v6
    v_and_b32 v7, 1, v0
    v_lshlrev_b32 v7, 4, v7
    v_and_b32 v48, 2, v0
    v_lshl_add_u32 v7, v48, 2, v7
    v_cndmask_b32 v6, v6, v7, s[62:63]
    v_add_u32 v5, v5, v6
    s_lshl_b32 s28, s15, 1
    s_add_u32 s28, s28, s14
    v_xor_b32 v4, s28, v4
    v_lshl_add_u32 v5, v4, 6, v5
    v_add_u32 v16, 16384, v5
    v_xor_b32 v17, 64, v16
    s_mov_b32 s36, 0x3f803f80
    s_mov_b32 s27, 0x20000
    s_mov_b32 s37, 0
    v_mov_b32 v18, 0
    v_mov_b32 v19, 0
    v_mov_b32 v20, 0
    v_mov_b32 v21, 0
    v_mov_b32 v22, 0
    v_mov_b32 v23, 0
    v_mov_b32 v64, 0
    v_mov_b32 v65, 0
    v_mov_b32 v66, 0
    v_mov_b32 v67, 0
    v_mov_b32 v68, 0
    v_mov_b32 v69, 0
    v_mov_b32 v70, 0
    v_mov_b32 v71, 0
    v_mov_b32 v72, 0
    v_mov_b32 v73, 0
    v_mov_b32 v74, 0
    v_mov_b32 v75, 0
    v_mov_b32 v76, 0
    v_mov_b32 v77, 0
    v_mov_b32 v78, 0
    v_mov_b32 v79, 0
    v_mov_b32 v80, 0
    v_mov_b32 v81, 0
    v_mov_b32 v82, 0
    v_mov_b32 v83, 0
    v_mov_b32 v84, 0
    v_mov_b32 v85, 0
    v_mov_b32 v86, 0
    v_mov_b32 v87, 0
    v_mov_b32 v88, 0
    v_mov_b32 v89, 0
    v_mov_b32 v90, 0
    v_mov_b32 v91, 0
    v_mov_b32 v92, 0
    v_mov_b32 v93, 0
    v_mov_b32 v94, 0
    v_mov_b32 v95, 0
    v_mov_b32 v96, 0
    v_mov_b32 v97, 0
    v_mov_b32 v98, 0
    v_mov_b32 v99, 0
    v_mov_b32 v100, 0
    v_mov_b32 v101, 0
    v_mov_b32 v102, 0
    v_mov_b32 v103, 0
    v_mov_b32 v104, 0
    v_mov_b32 v105, 0
    v_mov_b32 v106, 0
    v_mov_b32 v107, 0
    v_mov_b32 v108, 0
    v_mov_b32 v109, 0
    v_mov_b32 v110, 0
    v_mov_b32 v111, 0
    v_mov_b32 v112, 0
    v_mov_b32 v113, 0
    v_mov_b32 v114, 0
    v_mov_b32 v115, 0
    v_mov_b32 v116, 0
    v_mov_b32 v117, 0
    v_mov_b32 v118, 0
    v_mov_b32 v119, 0
    v_mov_b32 v120, 0
    v_mov_b32 v121, 0
    v_mov_b32 v122, 0
    v_mov_b32 v123, 0
    v_mov_b32 v124, 0
    v_mov_b32 v125, 0
    v_mov_b32 v126, 0
    v_mov_b32 v127, 0
    s_cmp_ge_u32 s12, 10
    s_cbranch_scc1 qkvs_v_setup
    s_mov_b32 s42, 81920
    s_mov_b32 s43, 1280
    s_mov_b32 s44, 1024
    s_mov_b32 s28, 5242880
    s_mov_b32 s26, 2621440
    s_cmp_ge_u32 s12, 5
    s_cmov_b32 s42, 163840
    s_cmov_b32 s43, 2560
    s_cmov_b32 s44, 2304
    s_cmov_b32 s28, 7864320
    s_cmov_b32 s26, 5242880
    s_cselect_b32 s29, 5, 0
    s_add_u32 s28, s28, s45
    s_add_u32 s24, s8, s28
    s_addc_u32 s25, s9, 0
    s_sub_u32 s29, s12, s29
    s_mul_i32 s40, s40, s43
    s_mul_i32 s41, s41, s43
    s_lshl_b32 s29, s29, 4
    s_lshl_b32 s28, s15, 3
    s_add_u32 s29, s29, s28
    v_lshlrev_b32 v6, 4, v3
    v_lshlrev_b32 v7, 3, v3
    v_add_u32 v7, s44, v7
    v_mov_b32 v51, 0x7fffff00
    s_xor_b32 s28, s14, 0
    s_lshl_b32 s28, s28, 2
    s_add_u32 s28, s28, s29
    s_add_u32 s30, s28, 0
    v_add_u32 v4, s30, v2
    v_mul_u32_u24 v5, 205, v4
    v_lshrrev_b32 v5, 10, v5
    v_mul_u32_u24 v48, 5, v5
    v_sub_u32 v4, v4, v48
    v_cmp_eq_u32 s[46:47], 2, v4
    v_cmp_lt_u32 s[60:61], 2, v4
    v_lshlrev_b32 v5, 1, v5
    v_mul_lo_u32 v5, v5, s42
    v_add_u32 v49, v5, v7
    v_cndmask_b32 v25, v51, v49, s[46:47]
    v_mov_b32 v48, 0
    v_mov_b32 v49, s42
    v_cndmask_b32 v48, v48, v49, s[60:61]
    v_add_u32 v5, v5, v48
    v_subrev_u32 v48, 3, v4
    v_cndmask_b32 v4, v4, v48, s[60:61]
    v_lshl_add_u32 v4, v4, 9, v6
    v_add_u32 v4, v4, v5
    v_cndmask_b32 v24, v4, v51, s[46:47]
    s_add_u32 s30, s28, 2
    v_add_u32 v4, s30, v2
    v_mul_u32_u24 v5, 205, v4
    v_lshrrev_b32 v5, 10, v5
    v_mul_u32_u24 v48, 5, v5
    v_sub_u32 v4, v4, v48
    v_cmp_eq_u32 s[48:49], 2, v4
    v_cmp_lt_u32 s[60:61], 2, v4
    v_lshlrev_b32 v5, 1, v5
    v_mul_lo_u32 v5, v5, s42
    v_add_u32 v49, v5, v7
    v_cndmask_b32 v27, v51, v49, s[48:49]
    v_mov_b32 v48, 0
    v_mov_b32 v49, s42
    v_cndmask_b32 v48, v48, v49, s[60:61]
    v_add_u32 v5, v5, v48
    v_subrev_u32 v48, 3, v4
    v_cndmask_b32 v4, v4, v48, s[60:61]
    v_lshl_add_u32 v4, v4, 9, v6
    v_add_u32 v4, v4, v5
    v_cndmask_b32 v26, v4, v51, s[48:49]
    s_xor_b32 s28, s14, 1
    s_lshl_b32 s28, s28, 2
    s_add_u32 s28, s28, s29
    s_add_u32 s30, s28, 0
    v_add_u32 v4, s30, v2
    v_mul_u32_u24 v5, 205, v4
    v_lshrrev_b32 v5, 10, v5
    v_mul_u32_u24 v48, 5, v5
    v_sub_u32 v4, v4, v48
    v_cmp_eq_u32 s[56:57], 2, v4
    v_cmp_lt_u32 s[60:61], 2, v4
    v_lshlrev_b32 v5, 1, v5
    v_mul_lo_u32 v5, v5, s42
    v_add_u32 v49, v5, v7
    v_cndmask_b32 v29, v51, v49, s[56:57]
    v_mov_b32 v48, 0
    v_mov_b32 v49, s42
    v_cndmask_b32 v48, v48, v49, s[60:61]
    v_add_u32 v5, v5, v48
    v_subrev_u32 v48, 3, v4
    v_cndmask_b32 v4, v4, v48, s[60:61]
    v_lshl_add_u32 v4, v4, 9, v6
    v_add_u32 v4, v4, v5
    v_cndmask_b32 v28, v4, v51, s[56:57]
    s_add_u32 s30, s28, 2
    v_add_u32 v4, s30, v2
    v_mul_u32_u24 v5, 205, v4
    v_lshrrev_b32 v5, 10, v5
    v_mul_u32_u24 v48, 5, v5
    v_sub_u32 v4, v4, v48
    v_cmp_eq_u32 s[58:59], 2, v4
    v_cmp_lt_u32 s[60:61], 2, v4
    v_lshlrev_b32 v5, 1, v5
    v_mul_lo_u32 v5, v5, s42
    v_add_u32 v49, v5, v7
    v_cndmask_b32 v31, v51, v49, s[58:59]
    v_mov_b32 v48, 0
    v_mov_b32 v49, s42
    v_cndmask_b32 v48, v48, v49, s[60:61]
    v_add_u32 v5, v5, v48
    v_subrev_u32 v48, 3, v4
    v_cndmask_b32 v4, v4, v48, s[60:61]
    v_lshl_add_u32 v4, v4, 9, v6
    v_add_u32 v4, v4, v5
    v_cndmask_b32 v30, v4, v51, s[58:59]
    s_barrier
    ds_read_b128 v[128:131], v8
    ds_read_b64_tr_b16 v[136:137], v16 offset:0
    ds_read_b64_tr_b16 v[138:139], v16 offset:1024
    ds_read_b64_tr_b16 v[140:141], v17 offset:0
    ds_read_b64_tr_b16 v[142:143], v17 offset:1024
    ds_read_b128 v[132:135], v12
qkvs_loop_qk:
    s_waitcnt lgkmcnt(3)
    v_mfma_f32_32x32x16_bf16 v[64:79], v[136:139], v[128:131], v[64:79]
    ds_read_b128 v[144:147], v9
    ds_read_b64_tr_b16 v[152:153], v16 offset:4096
    s_waitcnt lgkmcnt(3)
    v_mfma_f32_32x32x16_bf16 v[80:95], v[140:143], v[128:131], v[80:95]
    ds_read_b64_tr_b16 v[154:155], v16 offset:5120
    ds_read_b64_tr_b16 v[156:157], v17 offset:4096
    s_waitcnt lgkmcnt(4)
    v_mfma_f32_32x32x16_bf16 v[96:111], v[136:139], v[132:135], v[96:111]
    ds_read_b64_tr_b16 v[158:159], v17 offset:5120
    ds_read_b128 v[148:151], v13
    v_mfma_f32_32x32x16_bf16 v[112:127], v[140:143], v[132:135], v[112:127]
    v_dot2_f32_bf16 v18, v128, s36, v18
    v_dot2_f32_bf16 v20, v128, v128, v20
    v_dot2_f32_bf16 v22, v136, s36, v22
    v_dot2_f32_bf16 v19, v129, s36, v19
    v_dot2_f32_bf16 v21, v129, v129, v21
    v_dot2_f32_bf16 v23, v137, s36, v23
    v_dot2_f32_bf16 v18, v130, s36, v18
    v_dot2_f32_bf16 v20, v130, v130, v20
    v_dot2_f32_bf16 v22, v138, s36, v22
    v_dot2_f32_bf16 v19, v131, s36, v19
    v_dot2_f32_bf16 v21, v131, v131, v21
    v_dot2_f32_bf16 v23, v139, s36, v23
    s_waitcnt lgkmcnt(3)
    v_mfma_f32_32x32x16_bf16 v[64:79], v[152:155], v[144:147], v[64:79]
    ds_read_b128 v[128:131], v10
    ds_read_b64_tr_b16 v[136:137], v16 offset:8192
    s_waitcnt lgkmcnt(3)
    v_mfma_f32_32x32x16_bf16 v[80:95], v[156:159], v[144:147], v[80:95]
    ds_read_b64_tr_b16 v[138:139], v16 offset:9216
    ds_read_b64_tr_b16 v[140:141], v17 offset:8192
    s_waitcnt lgkmcnt(4)
    v_mfma_f32_32x32x16_bf16 v[96:111], v[152:155], v[148:151], v[96:111]
    ds_read_b64_tr_b16 v[142:143], v17 offset:9216
    ds_read_b128 v[132:135], v14
    v_mfma_f32_32x32x16_bf16 v[112:127], v[156:159], v[148:151], v[112:127]
    v_dot2_f32_bf16 v18, v144, s36, v18
    v_dot2_f32_bf16 v20, v144, v144, v20
    v_dot2_f32_bf16 v22, v152, s36, v22
    v_dot2_f32_bf16 v19, v145, s36, v19
    v_dot2_f32_bf16 v21, v145, v145, v21
    v_dot2_f32_bf16 v23, v153, s36, v23
    v_dot2_f32_bf16 v18, v146, s36, v18
    v_dot2_f32_bf16 v20, v146, v146, v20
    v_dot2_f32_bf16 v22, v154, s36, v22
    v_dot2_f32_bf16 v19, v147, s36, v19
    v_dot2_f32_bf16 v21, v147, v147, v21
    v_dot2_f32_bf16 v23, v155, s36, v23
    s_waitcnt lgkmcnt(3)
    v_mfma_f32_32x32x16_bf16 v[64:79], v[136:139], v[128:131], v[64:79]
    ds_read_b128 v[144:147], v11
    ds_read_b64_tr_b16 v[152:153], v16 offset:12288
    s_waitcnt lgkmcnt(3)
    v_mfma_f32_32x32x16_bf16 v[80:95], v[140:143], v[128:131], v[80:95]
    ds_read_b64_tr_b16 v[154:155], v16 offset:13312
    ds_read_b64_tr_b16 v[156:157], v17 offset:12288
    s_waitcnt lgkmcnt(4)
    v_mfma_f32_32x32x16_bf16 v[96:111], v[136:139], v[132:135], v[96:111]
    ds_read_b64_tr_b16 v[158:159], v17 offset:13312
    ds_read_b128 v[148:151], v15
    v_mfma_f32_32x32x16_bf16 v[112:127], v[140:143], v[132:135], v[112:127]
    v_dot2_f32_bf16 v18, v128, s36, v18
    v_dot2_f32_bf16 v20, v128, v128, v20
    v_dot2_f32_bf16 v22, v136, s36, v22
    v_dot2_f32_bf16 v19, v129, s36, v19
    v_dot2_f32_bf16 v21, v129, v129, v21
    v_dot2_f32_bf16 v23, v137, s36, v23
    v_dot2_f32_bf16 v18, v130, s36, v18
    v_dot2_f32_bf16 v20, v130, v130, v20
    v_dot2_f32_bf16 v22, v138, s36, v22
    v_dot2_f32_bf16 v19, v131, s36, v19
    v_dot2_f32_bf16 v21, v131, v131, v21
    v_dot2_f32_bf16 v23, v139, s36, v23
    s_add_u32 s37, s37, 1
    s_mov_b32 s39, 32768
    s_cmp_eq_u32 s37, 5
    s_cmov_b32 s39, 4294836224
    v_add_u32 v8, s39, v8
    v_add_u32 v9, s39, v9
    v_add_u32 v10, s39, v10
    v_add_u32 v11, s39, v11
    v_add_u32 v12, s39, v12
    v_add_u32 v13, s39, v13
    v_add_u32 v14, s39, v14
    v_add_u32 v15, s39, v15
    v_add_u32 v16, s39, v16
    v_add_u32 v17, s39, v17
    s_cmp_eq_u32 s37, 10
    s_waitcnt lgkmcnt(0)
    s_cbranch_scc1 qkvs_last_qk
    v_mfma_f32_32x32x16_bf16 v[64:79], v[152:155], v[144:147], v[64:79]
    s_barrier
    ds_read_b128 v[128:131], v8
    ds_read_b64_tr_b16 v[136:137], v16 offset:0
    v_mfma_f32_32x32x16_bf16 v[80:95], v[156:159], v[144:147], v[80:95]
    ds_read_b64_tr_b16 v[138:139], v16 offset:1024
    ds_read_b64_tr_b16 v[140:141], v17 offset:0
    v_mfma_f32_32x32x16_bf16 v[96:111], v[152:155], v[148:151], v[96:111]
    ds_read_b64_tr_b16 v[142:143], v17 offset:1024
    ds_read_b128 v[132:135], v12
    v_mfma_f32_32x32x16_bf16 v[112:127], v[156:159], v[148:151], v[112:127]
    v_dot2_f32_bf16 v18, v144, s36, v18
    v_dot2_f32_bf16 v20, v144, v144, v20
    v_dot2_f32_bf16 v22, v152, s36, v22
    v_dot2_f32_bf16 v19, v145, s36, v19
    v_dot2_f32_bf16 v21, v145, v145, v21
    v_dot2_f32_bf16 v23, v153, s36, v23
    v_dot2_f32_bf16 v18, v146, s36, v18
    v_dot2_f32_bf16 v20, v146, v146, v20
    v_dot2_f32_bf16 v22, v154, s36, v22
    v_dot2_f32_bf16 v19, v147, s36, v19
    v_dot2_f32_bf16 v21, v147, v147, v21
    v_dot2_f32_bf16 v23, v155, s36, v23
    s_branch qkvs_loop_qk
qkvs_last_qk:
    v_mfma_f32_32x32x16_bf16 v[64:79], v[152:155], v[144:147], v[64:79]
    v_mfma_f32_32x32x16_bf16 v[80:95], v[156:159], v[144:147], v[80:95]
    v_mfma_f32_32x32x16_bf16 v[96:111], v[152:155], v[148:151], v[96:111]
    v_mfma_f32_32x32x16_bf16 v[112:127], v[156:159], v[148:151], v[112:127]
    v_dot2_f32_bf16 v18, v144, s36, v18
    v_dot2_f32_bf16 v20, v144, v144, v20
    v_dot2_f32_bf16 v22, v152, s36, v22
    v_dot2_f32_bf16 v19, v145, s36, v19
    v_dot2_f32_bf16 v21, v145, v145, v21
    v_dot2_f32_bf16 v23, v153, s36, v23
    v_dot2_f32_bf16 v18, v146, s36, v18
    v_dot2_f32_bf16 v20, v146, v146, v20
    v_dot2_f32_bf16 v22, v154, s36, v22
    v_dot2_f32_bf16 v19, v147, s36, v19
    v_dot2_f32_bf16 v21, v147, v147, v21
    v_dot2_f32_bf16 v23, v155, s36, v23
    s_nop 0
    v_add_f32 v4, v18, v19
    v_add_f32 v5, v20, v21
    v_add_f32 v6, v22, v23
    v_mov_b32 v7, v4
    v_mov_b32 v8, v5
    v_mov_b32 v9, v6
    v_permlane32_swap_b32 v7, v4
    v_permlane32_swap_b32 v8, v5
    v_permlane32_swap_b32 v9, v6
    v_add_f32 v4, v4, v7
    v_add_f32 v5, v5, v8
    v_add_f32 v6, v6, v9
    v_mul_f32 v4, 0x3acccccd, v4
    v_mul_f32 v5, 0x3acccccd, v5
    v_fma_f32 v5, -v4, v4, v5
    v_max_f32 v5, 0, v5
    v_cvt_pk_bf16_f32 v7, v4, v5
    v_and_b32 v5, 0xffff0000, v7
    v_lshlrev_b32 v4, 16, v7
    v_add_f32 v5, 0x3727c5ac, v5
    v_cvt_pk_bf16_f32 v5, v5, v5
    v_and_b32 v5, 0xffff0000, v5
    v_sqrt_f32 v5, v5
    s_nop 0
    v_cvt_pk_bf16_f32 v5, v5, v5
    v_and_b32 v5, 0xffff0000, v5
    v_rcp_f32 v5, v5
    v_xor_b32 v8, 0x80000000, v4
    v_mul_f32 v56, s38, v5
    v_cvt_pk_bf16_f32 v9, v6, v6
    v_and_b32 v9, 0xffff0000, v9
    v_sub_f32 v10, v6, v9
    v_cvt_pk_bf16_f32 v160, v9, v10
    v_and_b32 v9, 0xffff0000, v160
    v_sub_f32 v10, v10, v9
    v_mov_b32 v9, 0
    v_cvt_pk_bf16_f32 v161, v10, v9
    s_lshl_b32 s28, s14, 8
    s_lshl_b32 s29, s15, 7
    s_add_u32 s28, s28, s29
    v_lshl_add_u32 v7, v3, 2, s28
    ds_write_b32 v7, v56 offset:4096
    ds_write_b32 v7, v8 offset:4608
    s_lshl_b32 s28, s15, 9
    s_lshl_b32 s29, s14, 8
    s_add_u32 s28, s28, s29
    v_lshl_add_u32 v9, v62, 3, s28
    ds_write_b64 v9, v[160:161] offset:5120
    s_lshl_b32 s29, s12, 10
    s_add_u32 s29, s29, 131072
    s_cmp_lg_u32 s11, 0
    s_cbranch_scc1 qkvs_nocs_qk
    buffer_store_dwordx2 v[160:161], v9, s[52:55], s29 offen sc0 sc1
qkvs_nocs_qk:
    s_waitcnt lgkmcnt(0)
    s_barrier
    v_xor_b32 v7, 128, v7
    v_xor_b32 v9, 256, v9
    ds_read_b32 v57, v7 offset:4096
    ds_read_b32 v10, v7 offset:4608
    ds_read_b64 v[162:163], v9 offset:5120
    v_mov_b32 v11, 0
    v_cndmask_b32 v11, v11, v8, s[50:51]
    v_lshrrev_b32 v59, 16, v11
    v_or_b32 v58, v59, v11
    s_waitcnt lgkmcnt(0)
    v_mov_b32 v11, 0
    v_cndmask_b32 v11, v11, v10, s[50:51]
    v_lshrrev_b32 v61, 16, v11
    v_or_b32 v60, v61, v11
    v_mfma_f32_32x32x8_bf16 v[64:79], v[160:161], v[58:59], v[64:79]
    v_mfma_f32_32x32x8_bf16 v[80:95], v[162:163], v[58:59], v[80:95]
    v_mfma_f32_32x32x8_bf16 v[96:111], v[160:161], v[60:61], v[96:111]
    v_mfma_f32_32x32x8_bf16 v[112:127], v[162:163], v[60:61], v[112:127]
    s_add_u32 s28, s40, s42
    s_add_u32 s29, s41, s42
    s_nop 6
    v_mul_f32 v164, v56, v64
    v_mul_f32 v165, v56, v65
    v_mul_f32 v166, v56, v66
    v_mul_f32 v167, v56, v67
    v_mul_f32 v168, v56, v68
    v_mul_f32 v169, v56, v69
    v_mul_f32 v170, v56, v70
    v_mul_f32 v171, v56, v71
    v_cvt_pk_bf16_f32 v172, v164, v165
    v_cvt_pk_bf16_f32 v173, v166, v167
    v_cvt_pk_bf16_f32 v174, v168, v169
    v_cvt_pk_bf16_f32 v175, v170, v171
    buffer_store_dwordx4 v[172:175], v24, s[24:27], s40 offen sc0 sc1
    s_cmp_eq_u64 s[46:47], 0
    s_cbranch_scc1 qkvs_ns1
    buffer_store_dwordx2 v[172:173], v25, s[24:27], s40 offen sc0 sc1
    buffer_store_dwordx2 v[174:175], v25, s[24:27], s28 offen sc0 sc1
qkvs_ns1:
    v_mul_f32 v176, v56, v72
    v_mul_f32 v177, v56, v73
    v_mul_f32 v178, v56, v74
    v_mul_f32 v179, v56, v75
    v_mul_f32 v180, v56, v76
    v_mul_f32 v181, v56, v77
    v_mul_f32 v182, v56, v78
    v_mul_f32 v183, v56, v79
    v_cvt_pk_bf16_f32 v184, v176, v177
    v_cvt_pk_bf16_f32 v185, v178, v179
    v_cvt_pk_bf16_f32 v186, v180, v181
    v_cvt_pk_bf16_f32 v187, v182, v183
    buffer_store_dwordx4 v[184:187], v26, s[24:27], s40 offen sc0 sc1
    s_cmp_eq_u64 s[48:49], 0
    s_cbranch_scc1 qkvs_ns2
    buffer_store_dwordx2 v[184:185], v27, s[24:27], s40 offen sc0 sc1
    buffer_store_dwordx2 v[186:187], v27, s[24:27], s28 offen sc0 sc1
qkvs_ns2:
    v_mul_f32 v164, v56, v80
    v_mul_f32 v165, v56, v81
    v_mul_f32 v166, v56, v82
    v_mul_f32 v167, v56, v83
    v_mul_f32 v168, v56, v84
    v_mul_f32 v169, v56, v85
    v_mul_f32 v170, v56, v86
    v_mul_f32 v171, v56, v87
    v_cvt_pk_bf16_f32 v172, v164, v165
    v_cvt_pk_bf16_f32 v173, v166, v167
    v_cvt_pk_bf16_f32 v174, v168, v169
    v_cvt_pk_bf16_f32 v175, v170, v171
    buffer_store_dwordx4 v[172:175], v28, s[24:27], s40 offen sc0 sc1
    s_cmp_eq_u64 s[56:57], 0
    s_cbranch_scc1 qkvs_ns3
    buffer_store_dwordx2 v[172:173], v29, s[24:27], s40 offen sc0 sc1
    buffer_store_dwordx2 v[174:175], v29, s[24:27], s28 offen sc0 sc1
qkvs_ns3:
    v_mul_f32 v176, v56, v88
    v_mul_f32 v177, v56, v89
    v_mul_f32 v178, v56, v90
    v_mul_f32 v179, v56, v91
    v_mul_f32 v180, v56, v92
    v_mul_f32 v181, v56, v93
    v_mul_f32 v182, v56, v94
    v_mul_f32 v183, v56, v95
    v_cvt_pk_bf16_f32 v184, v176, v177
    v_cvt_pk_bf16_f32 v185, v178, v179
    v_cvt_pk_bf16_f32 v186, v180, v181
    v_cvt_pk_bf16_f32 v187, v182, v183
    buffer_store_dwordx4 v[184:187], v30, s[24:27], s40 offen sc0 sc1
    s_cmp_eq_u64 s[58:59], 0
    s_cbranch_scc1 qkvs_ns4
    buffer_store_dwordx2 v[184:185], v31, s[24:27], s40 offen sc0 sc1
    buffer_store_dwordx2 v[186:187], v31, s[24:27], s28 offen sc0 sc1
qkvs_ns4:
    v_mul_f32 v164, v57, v96
    v_mul_f32 v165, v57, v97
    v_mul_f32 v166, v57, v98
    v_mul_f32 v167, v57, v99
    v_mul_f32 v168, v57, v100
    v_mul_f32 v169, v57, v101
    v_mul_f32 v170, v57, v102
    v_mul_f32 v171, v57, v103
    v_cvt_pk_bf16_f32 v172, v164, v165
    v_cvt_pk_bf16_f32 v173, v166, v167
    v_cvt_pk_bf16_f32 v174, v168, v169
    v_cvt_pk_bf16_f32 v175, v170, v171
    buffer_store_dwordx4 v[172:175], v24, s[24:27], s41 offen sc0 sc1
    s_cmp_eq_u64 s[46:47], 0
    s_cbranch_scc1 qkvs_ns5
    buffer_store_dwordx2 v[172:173], v25, s[24:27], s41 offen sc0 sc1
    buffer_store_dwordx2 v[174:175], v25, s[24:27], s29 offen sc0 sc1
qkvs_ns5:
    v_mul_f32 v176, v57, v104
    v_mul_f32 v177, v57, v105
    v_mul_f32 v178, v57, v106
    v_mul_f32 v179, v57, v107
    v_mul_f32 v180, v57, v108
    v_mul_f32 v181, v57, v109
    v_mul_f32 v182, v57, v110
    v_mul_f32 v183, v57, v111
    v_cvt_pk_bf16_f32 v184, v176, v177
    v_cvt_pk_bf16_f32 v185, v178, v179
    v_cvt_pk_bf16_f32 v186, v180, v181
    v_cvt_pk_bf16_f32 v187, v182, v183
    buffer_store_dwordx4 v[184:187], v26, s[24:27], s41 offen sc0 sc1
    s_cmp_eq_u64 s[48:49], 0
    s_cbranch_scc1 qkvs_ns6
    buffer_store_dwordx2 v[184:185], v27, s[24:27], s41 offen sc0 sc1
    buffer_store_dwordx2 v[186:187], v27, s[24:27], s29 offen sc0 sc1
qkvs_ns6:
    v_mul_f32 v164, v57, v112
    v_mul_f32 v165, v57, v113
    v_mul_f32 v166, v57, v114
    v_mul_f32 v167, v57, v115
    v_mul_f32 v168, v57, v116
    v_mul_f32 v169, v57, v117
    v_mul_f32 v170, v57, v118
    v_mul_f32 v171, v57, v119
    v_cvt_pk_bf16_f32 v172, v164, v165
    v_cvt_pk_bf16_f32 v173, v166, v167
    v_cvt_pk_bf16_f32 v174, v168, v169
    v_cvt_pk_bf16_f32 v175, v170, v171
    buffer_store_dwordx4 v[172:175], v28, s[24:27], s41 offen sc0 sc1
    s_cmp_eq_u64 s[56:57], 0
    s_cbranch_scc1 qkvs_ns7
    buffer_store_dwordx2 v[172:173], v29, s[24:27], s41 offen sc0 sc1
    buffer_store_dwordx2 v[174:175], v29, s[24:27], s29 offen sc0 sc1
qkvs_ns7:
    v_mul_f32 v176, v57, v120
    v_mul_f32 v177, v57, v121
    v_mul_f32 v178, v57, v122
    v_mul_f32 v179, v57, v123
    v_mul_f32 v180, v57, v124
    v_mul_f32 v181, v57, v125
    v_mul_f32 v182, v57, v126
    v_mul_f32 v183, v57, v127
    v_cvt_pk_bf16_f32 v184, v176, v177
    v_cvt_pk_bf16_f32 v185, v178, v179
    v_cvt_pk_bf16_f32 v186, v180, v181
    v_cvt_pk_bf16_f32 v187, v182, v183
    buffer_store_dwordx4 v[184:187], v30, s[24:27], s41 offen sc0 sc1
    s_cmp_eq_u64 s[58:59], 0
    s_cbranch_scc1 qkvs_ns8
    buffer_store_dwordx2 v[184:185], v31, s[24:27], s41 offen sc0 sc1
    buffer_store_dwordx2 v[186:187], v31, s[24:27], s29 offen sc0 sc1
qkvs_ns8:
    s_endpgm
qkvs_v_setup:
    s_add_u32 s28, s45, 7864320
    s_add_u32 s24, s8, s28
    s_addc_u32 s25, s9, 0
    s_mov_b32 s26, 5242880
    s_mul_i32 s40, s40, 2560
    s_mul_i32 s41, s41, 2560
    s_sub_u32 s29, s12, 10
    s_lshl_b32 s29, s29, 7
    s_lshl_b32 s28, s15, 6
    s_add_u32 s29, s29, s28
    s_mov_b32 s42, 163840
    v_mul_u32_u24 v6, 320, v2
    v_add_u32 v6, 1024, v6
    s_lshl_b32 s28, s13, 8
    v_lshl_add_u32 v26, v3, 2, s28
    v_lshl_add_u32 v27, v2, 4, s28
    s_xor_b32 s28, s14, 0
    s_lshl_b32 s28, s28, 5
    s_add_u32 s28, s28, s29
    v_add_u32 v4, s28, v3
    v_mul_u32_u24 v5, 3277, v4
    v_lshrrev_b32 v5, 16, v5
    v_mul_u32_u24 v48, 20, v5
    v_sub_u32 v4, v4, v48
    v_lshl_add_u32 v4, v4, 4, v6
    v_mul_lo_u32 v5, v5, s42
    v_add_u32 v24, v5, v4
    s_xor_b32 s28, s14, 1
    s_lshl_b32 s28, s28, 5
    s_add_u32 s28, s28, s29
    v_add_u32 v4, s28, v3
    v_mul_u32_u24 v5, 3277, v4
    v_lshrrev_b32 v5, 16, v5
    v_mul_u32_u24 v48, 20, v5
    v_sub_u32 v4, v4, v48
    v_lshl_add_u32 v4, v4, 4, v6
    v_mul_lo_u32 v5, v5, s42
    v_add_u32 v25, v5, v4
    s_barrier
    ds_read_b128 v[128:131], v8
    ds_read_b64_tr_b16 v[136:137], v16 offset:0
    ds_read_b64_tr_b16 v[138:139], v16 offset:1024
    ds_read_b64_tr_b16 v[140:141], v17 offset:0
    ds_read_b64_tr_b16 v[142:143], v17 offset:1024
    ds_read_b128 v[132:135], v12
qkvs_loop_v:
    s_waitcnt lgkmcnt(3)
    v_mfma_f32_32x32x16_bf16 v[64:79], v[128:131], v[136:139], v[64:79]
    ds_read_b128 v[144:147], v9
    ds_read_b64_tr_b16 v[152:153], v16 offset:4096
    s_waitcnt lgkmcnt(3)
    v_mfma_f32_32x32x16_bf16 v[80:95], v[128:131], v[140:143], v[80:95]
    ds_read_b64_tr_b16 v[154:155], v16 offset:5120
    ds_read_b64_tr_b16 v[156:157], v17 offset:4096
    s_waitcnt lgkmcnt(4)
    v_mfma_f32_32x32x16_bf16 v[96:111], v[132:135], v[136:139], v[96:111]
    ds_read_b64_tr_b16 v[158:159], v17 offset:5120
    ds_read_b128 v[148:151], v13
    v_mfma_f32_32x32x16_bf16 v[112:127], v[132:135], v[140:143], v[112:127]
    v_dot2_f32_bf16 v18, v128, s36, v18
    v_dot2_f32_bf16 v20, v128, v128, v20
    v_dot2_f32_bf16 v22, v136, s36, v22
    v_dot2_f32_bf16 v19, v129, s36, v19
    v_dot2_f32_bf16 v21, v129, v129, v21
    v_dot2_f32_bf16 v23, v137, s36, v23
    v_dot2_f32_bf16 v18, v130, s36, v18
    v_dot2_f32_bf16 v20, v130, v130, v20
    v_dot2_f32_bf16 v22, v138, s36, v22
    v_dot2_f32_bf16 v19, v131, s36, v19
    v_dot2_f32_bf16 v21, v131, v131, v21
    v_dot2_f32_bf16 v23, v139, s36, v23
    s_waitcnt lgkmcnt(3)
    v_mfma_f32_32x32x16_bf16 v[64:79], v[144:147], v[152:155], v[64:79]
    ds_read_b128 v[128:131], v10
    ds_read_b64_tr_b16 v[136:137], v16 offset:8192
    s_waitcnt lgkmcnt(3)
    v_mfma_f32_32x32x16_bf16 v[80:95], v[144:147], v[156:159], v[80:95]
    ds_read_b64_tr_b16 v[138:139], v16 offset:9216
    ds_read_b64_tr_b16 v[140:141], v17 offset:8192
    s_waitcnt lgkmcnt(4)
    v_mfma_f32_32x32x16_bf16 v[96:111], v[148:151], v[152:155], v[96:111]
    ds_read_b64_tr_b16 v[142:143], v17 offset:9216
    ds_read_b128 v[132:135], v14
    v_mfma_f32_32x32x16_bf16 v[112:127], v[148:151], v[156:159], v[112:127]
    v_dot2_f32_bf16 v18, v144, s36, v18
    v_dot2_f32_bf16 v20, v144, v144, v20
    v_dot2_f32_bf16 v22, v152, s36, v22
    v_dot2_f32_bf16 v19, v145, s36, v19
    v_dot2_f32_bf16 v21, v145, v145, v21
    v_dot2_f32_bf16 v23, v153, s36, v23
    v_dot2_f32_bf16 v18, v146, s36, v18
    v_dot2_f32_bf16 v20, v146, v146, v20
    v_dot2_f32_bf16 v22, v154, s36, v22
    v_dot2_f32_bf16 v19, v147, s36, v19
    v_dot2_f32_bf16 v21, v147, v147, v21
    v_dot2_f32_bf16 v23, v155, s36, v23
    s_waitcnt lgkmcnt(3)
    v_mfma_f32_32x32x16_bf16 v[64:79], v[128:131], v[136:139], v[64:79]
    ds_read_b128 v[144:147], v11
    ds_read_b64_tr_b16 v[152:153], v16 offset:12288
    s_waitcnt lgkmcnt(3)
    v_mfma_f32_32x32x16_bf16 v[80:95], v[128:131], v[140:143], v[80:95]
    ds_read_b64_tr_b16 v[154:155], v16 offset:13312
    ds_read_b64_tr_b16 v[156:157], v17 offset:12288
    s_waitcnt lgkmcnt(4)
    v_mfma_f32_32x32x16_bf16 v[96:111], v[132:135], v[136:139], v[96:111]
    ds_read_b64_tr_b16 v[158:159], v17 offset:13312
    ds_read_b128 v[148:151], v15
    v_mfma_f32_32x32x16_bf16 v[112:127], v[132:135], v[140:143], v[112:127]
    v_dot2_f32_bf16 v18, v128, s36, v18
    v_dot2_f32_bf16 v20, v128, v128, v20
    v_dot2_f32_bf16 v22, v136, s36, v22
    v_dot2_f32_bf16 v19, v129, s36, v19
    v_dot2_f32_bf16 v21, v129, v129, v21
    v_dot2_f32_bf16 v23, v137, s36, v23
    v_dot2_f32_bf16 v18, v130, s36, v18
    v_dot2_f32_bf16 v20, v130, v130, v20
    v_dot2_f32_bf16 v22, v138, s36, v22
    v_dot2_f32_bf16 v19, v131, s36, v19
    v_dot2_f32_bf16 v21, v131, v131, v21
    v_dot2_f32_bf16 v23, v139, s36, v23
    s_add_u32 s37, s37, 1
    s_mov_b32 s39, 32768
    s_cmp_eq_u32 s37, 5
    s_cmov_b32 s39, 4294836224
    v_add_u32 v8, s39, v8
    v_add_u32 v9, s39, v9
    v_add_u32 v10, s39, v10
    v_add_u32 v11, s39, v11
    v_add_u32 v12, s39, v12
    v_add_u32 v13, s39, v13
    v_add_u32 v14, s39, v14
    v_add_u32 v15, s39, v15
    v_add_u32 v16, s39, v16
    v_add_u32 v17, s39, v17
    s_cmp_eq_u32 s37, 10
    s_waitcnt lgkmcnt(0)
    s_cbranch_scc1 qkvs_last_v
    v_mfma_f32_32x32x16_bf16 v[64:79], v[144:147], v[152:155], v[64:79]
    s_barrier
    ds_read_b128 v[128:131], v8
    ds_read_b64_tr_b16 v[136:137], v16 offset:0
    v_mfma_f32_32x32x16_bf16 v[80:95], v[144:147], v[156:159], v[80:95]
    ds_read_b64_tr_b16 v[138:139], v16 offset:1024
    ds_read_b64_tr_b16 v[140:141], v17 offset:0
    v_mfma_f32_32x32x16_bf16 v[96:111], v[148:151], v[152:155], v[96:111]
    ds_read_b64_tr_b16 v[142:143], v17 offset:1024
    ds_read_b128 v[132:135], v12
    v_mfma_f32_32x32x16_bf16 v[112:127], v[148:151], v[156:159], v[112:127]
    v_dot2_f32_bf16 v18, v144, s36, v18
    v_dot2_f32_bf16 v20, v144, v144, v20
    v_dot2_f32_bf16 v22, v152, s36, v22
    v_dot2_f32_bf16 v19, v145, s36, v19
    v_dot2_f32_bf16 v21, v145, v145, v21
    v_dot2_f32_bf16 v23, v153, s36, v23
    v_dot2_f32_bf16 v18, v146, s36, v18
    v_dot2_f32_bf16 v20, v146, v146, v20
    v_dot2_f32_bf16 v22, v154, s36, v22
    v_dot2_f32_bf16 v19, v147, s36, v19
    v_dot2_f32_bf16 v21, v147, v147, v21
    v_dot2_f32_bf16 v23, v155, s36, v23
    s_branch qkvs_loop_v
qkvs_last_v:
    v_mfma_f32_32x32x16_bf16 v[64:79], v[144:147], v[152:155], v[64:79]
    v_mfma_f32_32x32x16_bf16 v[80:95], v[144:147], v[156:159], v[80:95]
    v_mfma_f32_32x32x16_bf16 v[96:111], v[148:151], v[152:155], v[96:111]
    v_mfma_f32_32x32x16_bf16 v[112:127], v[148:151], v[156:159], v[112:127]
    v_dot2_f32_bf16 v18, v144, s36, v18
    v_dot2_f32_bf16 v20, v144, v144, v20
    v_dot2_f32_bf16 v22, v152, s36, v22
    v_dot2_f32_bf16 v19, v145, s36, v19
    v_dot2_f32_bf16 v21, v145, v145, v21
    v_dot2_f32_bf16 v23, v153, s36, v23
    v_dot2_f32_bf16 v18, v146, s36, v18
    v_dot2_f32_bf16 v20, v146, v146, v20
    v_dot2_f32_bf16 v22, v154, s36, v22
    v_dot2_f32_bf16 v19, v147, s36, v19
    v_dot2_f32_bf16 v21, v147, v147, v21
    v_dot2_f32_bf16 v23, v155, s36, v23
    s_nop 0
    v_add_f32 v4, v18, v19
    v_add_f32 v5, v20, v21
    v_add_f32 v6, v22, v23
    v_mov_b32 v7, v4
    v_mov_b32 v8, v5
    v_mov_b32 v9, v6
    v_permlane32_swap_b32 v7, v4
    v_permlane32_swap_b32 v8, v5
    v_permlane32_swap_b32 v9, v6
    v_add_f32 v4, v4, v7
    v_add_f32 v5, v5, v8
    v_add_f32 v6, v6, v9
    v_mul_f32 v4, 0x3acccccd, v4
    v_mul_f32 v5, 0x3acccccd, v5
    v_fma_f32 v5, -v4, v4, v5
    v_max_f32 v5, 0, v5
    v_cvt_pk_bf16_f32 v7, v4, v5
    v_and_b32 v5, 0xffff0000, v7
    v_lshlrev_b32 v4, 16, v7
    v_add_f32 v5, 0x3727c5ac, v5
    v_cvt_pk_bf16_f32 v5, v5, v5
    v_and_b32 v5, 0xffff0000, v5
    v_sqrt_f32 v5, v5
    s_nop 0
    v_cvt_pk_bf16_f32 v5, v5, v5
    v_and_b32 v5, 0xffff0000, v5
    v_rcp_f32 v5, v5
    v_xor_b32 v8, 0x80000000, v4
    v_mul_f32 v56, s38, v5
    v_cvt_pk_bf16_f32 v9, v6, v6
    v_and_b32 v9, 0xffff0000, v9
    v_sub_f32 v10, v6, v9
    v_cvt_pk_bf16_f32 v160, v9, v10
    v_and_b32 v9, 0xffff0000, v160
    v_sub_f32 v10, v10, v9
    v_mov_b32 v9, 0
    v_cvt_pk_bf16_f32 v161, v10, v9
    s_lshl_b32 s28, s14, 8
    s_lshl_b32 s29, s15, 7
    s_add_u32 s28, s28, s29
    v_lshl_add_u32 v7, v3, 2, s28
    ds_write_b32 v7, v56 offset:4096
    ds_write_b32 v7, v8 offset:4608
    s_lshl_b32 s28, s15, 9
    s_lshl_b32 s29, s14, 8
    s_add_u32 s28, s28, s29
    v_lshl_add_u32 v9, v62, 3, s28
    ds_write_b64 v9, v[160:161] offset:5120
    s_lshl_b32 s29, s12, 10
    s_add_u32 s29, s29, 131072
    s_cmp_lg_u32 s11, 0
    s_cbranch_scc1 qkvs_nocs_v
    buffer_store_dwordx2 v[160:161], v9, s[52:55], s29 offen sc0 sc1
qkvs_nocs_v:
    s_waitcnt lgkmcnt(0)
    s_barrier
    v_xor_b32 v7, 128, v7
    v_xor_b32 v9, 256, v9
    ds_read_b32 v57, v7 offset:4096
    ds_read_b32 v10, v7 offset:4608
    ds_read_b64 v[162:163], v9 offset:5120
    v_mov_b32 v11, 0
    v_cndmask_b32 v11, v11, v8, s[50:51]
    v_lshrrev_b32 v59, 16, v11
    v_or_b32 v58, v59, v11
    s_waitcnt lgkmcnt(0)
    v_mov_b32 v11, 0
    v_cndmask_b32 v11, v11, v10, s[50:51]
    v_lshrrev_b32 v61, 16, v11
    v_or_b32 v60, v61, v11
    v_mfma_f32_32x32x8_bf16 v[64:79], v[58:59], v[160:161], v[64:79]
    v_mfma_f32_32x32x8_bf16 v[80:95], v[58:59], v[162:163], v[80:95]
    v_mfma_f32_32x32x8_bf16 v[96:111], v[60:61], v[160:161], v[96:111]
    v_mfma_f32_32x32x8_bf16 v[112:127], v[60:61], v[162:163], v[112:127]
    ds_write_b32 v26, v56
    ds_write_b32 v26, v57 offset:128
    s_waitcnt lgkmcnt(0)
    ds_read_b128 v[160:163], v27 offset:0
    ds_read_b128 v[164:167], v27 offset:32
    ds_read_b128 v[168:171], v27 offset:64
    ds_read_b128 v[172:175], v27 offset:96
    ds_read_b128 v[176:179], v27 offset:128
    ds_read_b128 v[180:183], v27 offset:160
    ds_read_b128 v[184:187], v27 offset:192
    ds_read_b128 v[188:191], v27 offset:224
    s_waitcnt lgkmcnt(0)
    v_mul_f32 v32, v160, v64
    v_mul_f32 v33, v161, v65
    v_mul_f32 v34, v162, v66
    v_mul_f32 v35, v163, v67
    v_mul_f32 v36, v164, v68
    v_mul_f32 v37, v165, v69
    v_mul_f32 v38, v166, v70
    v_mul_f32 v39, v167, v71
    v_cvt_pk_bf16_f32 v40, v32, v33
    v_cvt_pk_bf16_f32 v41, v34, v35
    v_cvt_pk_bf16_f32 v42, v36, v37
    v_cvt_pk_bf16_f32 v43, v38, v39
    buffer_store_dwordx4 v[40:43], v24, s[24:27], s40 offen offset:0 sc0 sc1
    v_mul_f32 v44, v168, v72
    v_mul_f32 v45, v169, v73
    v_mul_f32 v46, v170, v74
    v_mul_f32 v47, v171, v75
    v_mul_f32 v48, v172, v76
    v_mul_f32 v49, v173, v77
    v_mul_f32 v50, v174, v78
    v_mul_f32 v51, v175, v79
    v_cvt_pk_bf16_f32 v52, v44, v45
    v_cvt_pk_bf16_f32 v53, v46, v47
    v_cvt_pk_bf16_f32 v54, v48, v49
    v_cvt_pk_bf16_f32 v55, v50, v51
    buffer_store_dwordx4 v[52:55], v24, s[24:27], s40 offen offset:640 sc0 sc1
    v_mul_f32 v32, v160, v80
    v_mul_f32 v33, v161, v81
    v_mul_f32 v34, v162, v82
    v_mul_f32 v35, v163, v83
    v_mul_f32 v36, v164, v84
    v_mul_f32 v37, v165, v85
    v_mul_f32 v38, v166, v86
    v_mul_f32 v39, v167, v87
    v_cvt_pk_bf16_f32 v40, v32, v33
    v_cvt_pk_bf16_f32 v41, v34, v35
    v_cvt_pk_bf16_f32 v42, v36, v37
    v_cvt_pk_bf16_f32 v43, v38, v39
    buffer_store_dwordx4 v[40:43], v25, s[24:27], s40 offen offset:0 sc0 sc1
    v_mul_f32 v44, v168, v88
    v_mul_f32 v45, v169, v89
    v_mul_f32 v46, v170, v90
    v_mul_f32 v47, v171, v91
    v_mul_f32 v48, v172, v92
    v_mul_f32 v49, v173, v93
    v_mul_f32 v50, v174, v94
    v_mul_f32 v51, v175, v95
    v_cvt_pk_bf16_f32 v52, v44, v45
    v_cvt_pk_bf16_f32 v53, v46, v47
    v_cvt_pk_bf16_f32 v54, v48, v49
    v_cvt_pk_bf16_f32 v55, v50, v51
    buffer_store_dwordx4 v[52:55], v25, s[24:27], s40 offen offset:640 sc0 sc1
    v_mul_f32 v32, v176, v96
    v_mul_f32 v33, v177, v97
    v_mul_f32 v34, v178, v98
    v_mul_f32 v35, v179, v99
    v_mul_f32 v36, v180, v100
    v_mul_f32 v37, v181, v101
    v_mul_f32 v38, v182, v102
    v_mul_f32 v39, v183, v103
    v_cvt_pk_bf16_f32 v40, v32, v33
    v_cvt_pk_bf16_f32 v41, v34, v35
    v_cvt_pk_bf16_f32 v42, v36, v37
    v_cvt_pk_bf16_f32 v43, v38, v39
    buffer_store_dwordx4 v[40:43], v24, s[24:27], s41 offen offset:0 sc0 sc1
    v_mul_f32 v44, v184, v104
    v_mul_f32 v45, v185, v105
    v_mul_f32 v46, v186, v106
    v_mul_f32 v47, v187, v107
    v_mul_f32 v48, v188, v108
    v_mul_f32 v49, v189, v109
    v_mul_f32 v50, v190, v110
    v_mul_f32 v51, v191, v111
    v_cvt_pk_bf16_f32 v52, v44, v45
    v_cvt_pk_bf16_f32 v53, v46, v47
    v_cvt_pk_bf16_f32 v54, v48, v49
    v_cvt_pk_bf16_f32 v55, v50, v51
    buffer_store_dwordx4 v[52:55], v24, s[24:27], s41 offen offset:640 sc0 sc1
    v_mul_f32 v32, v176, v112
    v_mul_f32 v33, v177, v113
    v_mul_f32 v34, v178, v114
    v_mul_f32 v35, v179, v115
    v_mul_f32 v36, v180, v116
    v_mul_f32 v37, v181, v117
    v_mul_f32 v38, v182, v118
    v_mul_f32 v39, v183, v119
    v_cvt_pk_bf16_f32 v40, v32, v33
    v_cvt_pk_bf16_f32 v41, v34, v35
    v_cvt_pk_bf16_f32 v42, v36, v37
    v_cvt_pk_bf16_f32 v43, v38, v39
    buffer_store_dwordx4 v[40:43], v25, s[24:27], s41 offen offset:0 sc0 sc1
    v_mul_f32 v44, v184, v120
    v_mul_f32 v45, v185, v121
    v_mul_f32 v46, v186, v122
    v_mul_f32 v47, v187, v123
    v_mul_f32 v48, v188, v124
    v_mul_f32 v49, v189, v125
    v_mul_f32 v50, v190, v126
    v_mul_f32 v51, v191, v127
    v_cvt_pk_bf16_f32 v52, v44, v45
    v_cvt_pk_bf16_f32 v53, v46, v47
    v_cvt_pk_bf16_f32 v54, v48, v49
    v_cvt_pk_bf16_f32 v55, v50, v51
    buffer_store_dwordx4 v[52:55], v25, s[24:27], s41 offen offset:640 sc0 sc1
    s_endpgm
qkvs_aux:

qkvs_aux_cnt:
    v_lshlrev_b32 v1, 4, v0
    v_mov_b32 v4, 0
    v_mov_b32 v5, 0
    v_mov_b32 v6, 0
    v_mov_b32 v7, 0
    s_mov_b32 s54, 262144
    s_mov_b32 s55, 0x20000
    s_lshl_b32 s29, s11, 14
    s_add_u32 s30, s29, 16384
    s_waitcnt lgkmcnt(0)
    s_add_u32 s52, s8, 0xE60000
    s_addc_u32 s53, s9, 0
qkvs_aux_cl:
    buffer_store_dwordx4 v[4:7], v1, s[52:55], s29 offen sc0 sc1
    s_add_u32 s29, s29, 8192
    s_cmp_lt_u32 s29, s30
    s_cbranch_scc1 qkvs_aux_cl
    s_endpgm
.globl fus2_kernel
.p2align 8
.type fus2_kernel,@function
fus2_kernel:
    s_load_dwordx2 s[4:5], s[0:1], 64
    s_load_dwordx2 s[52:53], s[0:1], 64
    s_mov_b32 s10, 33554432
    s_mov_b32 s54, 0
    s_mov_b32 s57, 15204352
    s_mov_b32 s58, 50331648
    s_branch attA_body
.globl fus0_kernel
.p2align 8
.type fus0_kernel,@function
fus0_kernel:
    s_load_dwordx2 s[4:5], s[0:1], 0
    s_load_dwordx2 s[52:53], s[0:1], 64
    s_mov_b32 s10, 0
    s_mov_b32 s54, 1
    s_mov_b32 s57, 15073280
    s_mov_b32 s58, 16777216
attA_body:
    s_mov_b32 s55, 13303808
    s_mov_b32 s56, 13254656
    s_mov_b32 s59, 0
    s_load_dwordx2 s[8:9], s[0:1], 64
    s_load_dwordx2 s[6:7], s[0:1], 32
    s_cmp_ge_u32 s2, 256
    s_cbranch_scc1 attA_end
    s_and_b32 s11, s2, 7
    s_lshl_b32 s11, s11, 2
    s_lshr_b32 s28, s2, 3
    s_and_b32 s28, s28, 3
    s_add_u32 s11, s11, s28
    s_lshr_b32 s12, s2, 5
    v_lshrrev_b32 v1, 6, v0
    v_and_b32 v0, 63, v0
    v_readfirstlane_b32 s13, v1
    s_mul_i32 s28, s11, 163840
    s_add_u32 s28, s28, 7864320
    s_add_u32 s28, s28, s10
    s_mul_i32 s29, s12, 20480
    s_add_u32 s28, s28, s29
    s_sub_u32 s28, s28, 20480
    s_mov_b32 s18, 40960
    s_mov_b32 s19, 0x20000
    v_lshlrev_b32 v3, 4, v0
    s_mul_i32 s30, s13, 5120
    s_waitcnt lgkmcnt(0)
    s_add_u32 s16, s8, s28
    s_addc_u32 s17, s9, 0
    s_cmp_eq_u32 s13, 8
    s_cbranch_scc0 attA_comp
    s_mul_i32 s29, s12, 102400
    s_add_u32 s29, s29, s55
    s_add_u32 s16, s8, s29
    s_addc_u32 s17, s9, 0
    s_mov_b32 s18, 102400
    s_mov_b32 s30, 0
    s_mov_b32 s31, 12
attA_ldw0:
    s_mov_b32 m0, s30
    s_sub_u32 s31, s31, 1
    buffer_load_dwordx4 v3, s[16:19], s30 offen offset:0 lds
    buffer_load_dwordx4 v3, s[16:19], s30 offen offset:1024 lds
    buffer_load_dwordx4 v3, s[16:19], s30 offen offset:2048 lds
    buffer_load_dwordx4 v3, s[16:19], s30 offen offset:3072 lds
    s_add_u32 s30, s30, 4096
    s_cmp_lg_u32 s31, 0
    s_cbranch_scc1 attA_ldw0
    s_barrier
    s_mov_b32 s31, 13
attA_ldw1:
    s_waitcnt vmcnt(59)
    s_mov_b32 m0, s30
    s_sub_u32 s31, s31, 1
    buffer_load_dwordx4 v3, s[16:19], s30 offen offset:0 lds
    buffer_load_dwordx4 v3, s[16:19], s30 offen offset:1024 lds
    buffer_load_dwordx4 v3, s[16:19], s30 offen offset:2048 lds
    buffer_load_dwordx4 v3, s[16:19], s30 offen offset:3072 lds
    s_add_u32 s30, s30, 4096
    s_cmp_lg_u32 s31, 0
    s_cbranch_scc1 attA_ldw1
    s_add_u32 s20, s8, 13303808
    s_addc_u32 s21, s9, 0
    s_mov_b32 s22, 819200
    s_mov_b32 s23, 0x20000
    s_mov_b32 s24, s6
    s_mov_b32 s25, s7
    s_mov_b32 s26, 2457600
    s_mov_b32 s27, 0x20000
    s_lshr_b32 s28, s2, 3
    v_lshlrev_b32 v8, 7, v0
    s_lshl_b32 s29, s28, 15
    v_lshrrev_b32 v8, 4, v0
    v_mul_u32_u24 v8, 3840, v8
    v_and_b32 v9, 15, v0
    v_lshl_add_u32 v8, v9, 7, v8
    s_mul_i32 s29, s28, 76800
    s_and_b32 s33, s2, 1
    s_lshl_b32 s33, s33, 11
    s_add_u32 s29, s29, s33
    s_add_u32 s33, s29, 0
    buffer_load_dword v16, v8, s[24:27], s33 offen
    s_add_u32 s33, s29, 15360
    buffer_load_dword v17, v8, s[24:27], s33 offen
    s_add_u32 s33, s29, 30720
    buffer_load_dword v18, v8, s[24:27], s33 offen
    s_add_u32 s33, s29, 46080
    buffer_load_dword v19, v8, s[24:27], s33 offen
    s_add_u32 s33, s29, 61440
    buffer_load_dword v20, v8, s[24:27], s33 offen
    s_barrier
    s_barrier
    s_waitcnt vmcnt(0)
    s_barrier
    s_branch opq_w8
attA_end:
    s_endpgm
attA_comp:
    s_add_u32 m0, s30, 102400
    s_mul_i32 s28, s11, 81920
    buffer_load_dwordx4 v3, s[16:19], s30 offen offset:0 lds
    buffer_load_dwordx4 v3, s[16:19], s30 offen offset:1024 lds
    buffer_load_dwordx4 v3, s[16:19], s30 offen offset:2048 lds
    buffer_load_dwordx4 v3, s[16:19], s30 offen offset:3072 lds
    s_add_u32 s30, s30, 4096
    s_add_u32 m0, s30, 102400
    s_nop 0
    buffer_load_dwordx4 v3, s[16:19], s30 offen lds
    s_mul_i32 s29, s12, 10240
    s_add_u32 s28, s28, s29
    s_mul_i32 s29, s13, 1280
    s_add_u32 s28, s28, s29
    s_add_u32 s28, s28, 5242880
    s_add_u32 s28, s28, s10
    s_mov_b32 s22, 1280
    s_mov_b32 s23, 0x20000
    v_lshlrev_b32 v7, 3, v0
    v_add_u32 v7, 1024, v7
    s_add_u32 s20, s8, s28
    s_addc_u32 s21, s9, 0
    buffer_load_dwordx4 v[8:11], v3, s[20:23], 0 offen
    buffer_load_dwordx2 v[12:13], v7, s[20:23], 0 offen

    s_add_u32 s29, s10, 2621440
    s_mov_b32 s26, 2621440
    s_mov_b32 s27, 0x20000
    s_add_u32 s24, s8, s29
    s_addc_u32 s25, s9, 0
    v_lshrrev_b32 v1, 5, v0
    v_and_b32 v2, 31, v0
    v_and_b32 v7, 0x33, v0
    v_and_b32 v5, 4, v0
    v_lshl_add_u32 v7, v5, 1, v7
    v_and_b32 v5, 8, v0
    v_lshrrev_b32 v5, 1, v5
    v_add_u32 v7, v5, v7
    v_lshlrev_b32 v3, 4, v7
    v_and_b32 v7, 31, v7
    v_lshlrev_b32 v4, 3, v7
    v_add_u32 v4, 2304, v4
    v_mul_u32_u24 v5, 320, v1
    v_lshl_add_u32 v5, v2, 4, v5
    v_add_u32 v5, 1024, v5
    s_lshl_b32 s28, s12, 8
    s_lshl_b32 s29, s13, 5
    s_add_u32 s28, s28, s29
    v_add_u32 v46, s28, v2
    v_lshlrev_b32 v46, 3, v46
    v_lshlrev_b32 v6, 3, v1
    v_lshl_add_u32 v6, v46, 1, v6
    s_mov_b32 s32, 0x000fffff
    s_mov_b32 s33, 0x000fffff
    s_lshl_b32 s39, s11, 16
    s_add_u32 s34, s39, 32768
    s_lshl_b32 s35, s11, 14
    s_add_u32 s35, s35, 2097152
    s_mov_b32 s48, 0
    v_mov_b32 v47, 0xdddddddd
    s_mov_b32 s49, 99
    s_cmp_lt_u32 s13, 4
    s_cmov_b32 s49, 7
    s_setprio 1
    s_cbranch_scc0 attA_prio
    s_setprio 2
attA_prio:
    v_cmp_eq_u32 s[40:41], 20, v2
    v_mov_b32 v32, 0
    v_mov_b32 v33, 0x3f803f80
    v_cndmask_b32 v20, v32, v33, s[40:41]
    v_cndmask_b32 v21, v32, v33, s[40:41]
    v_cndmask_b32 v22, v32, v33, s[40:41]
    v_cndmask_b32 v23, v32, v33, s[40:41]
    v_cndmask_b32 v24, v32, v33, s[40:41]
    v_cndmask_b32 v25, v32, v33, s[40:41]
    v_cndmask_b32 v26, v32, v33, s[40:41]
    v_cndmask_b32 v27, v32, v33, s[40:41]
    v_cndmask_b32 v28, v32, v33, s[40:41]
    v_cndmask_b32 v29, v32, v33, s[40:41]
    v_cndmask_b32 v30, v32, v33, s[40:41]
    v_cndmask_b32 v31, v32, v33, s[40:41]
    s_mul_i32 s28, s13, 2560
    s_add_u32 s28, s28, 102400
    v_add_u32 v3, s28, v3
    v_add_u32 v4, s28, v4
    v_add_u32 v5, s28, v5
    s_add_u32 s36, s13, 1
    s_cmp_eq_u32 s12, 0
    s_cselect_b32 s36, s36, 99
    v_lshlrev_b32 v7, 3, v1
    v_sub_u32 v7, v2, v7
    v_mov_b32 v32, 0xf149f2ca
    v_mov_b32 v33, 0
    v_cmp_le_i32 s[40:41], 0, v7
    v_cmp_le_i32 s[42:43], 1, v7
    v_cmp_le_i32 s[44:45], 2, v7
    v_cmp_le_i32 s[46:47], 3, v7
    v_cndmask_b32 v112, v32, v33, s[40:41]
    v_cndmask_b32 v128, v33, v32, s[40:41]
    v_cndmask_b32 v113, v32, v33, s[42:43]
    v_cndmask_b32 v129, v33, v32, s[42:43]
    v_cndmask_b32 v114, v32, v33, s[44:45]
    v_cndmask_b32 v130, v33, v32, s[44:45]
    v_cndmask_b32 v115, v32, v33, s[46:47]
    v_cndmask_b32 v131, v33, v32, s[46:47]
    v_cmp_le_i32 s[40:41], 4, v7
    v_cmp_le_i32 s[42:43], 5, v7
    v_cmp_le_i32 s[44:45], 6, v7
    v_cmp_le_i32 s[46:47], 7, v7
    v_cndmask_b32 v116, v32, v33, s[40:41]
    v_cndmask_b32 v132, v33, v32, s[40:41]
    v_cndmask_b32 v117, v32, v33, s[42:43]
    v_cndmask_b32 v133, v33, v32, s[42:43]
    v_cndmask_b32 v118, v32, v33, s[44:45]
    v_cndmask_b32 v134, v33, v32, s[44:45]
    v_cndmask_b32 v119, v32, v33, s[46:47]
    v_cndmask_b32 v135, v33, v32, s[46:47]
    v_cmp_le_i32 s[40:41], 16, v7
    v_cmp_le_i32 s[42:43], 17, v7
    v_cmp_le_i32 s[44:45], 18, v7
    v_cmp_le_i32 s[46:47], 19, v7
    v_cndmask_b32 v120, v32, v33, s[40:41]
    v_cndmask_b32 v136, v33, v32, s[40:41]
    v_cndmask_b32 v121, v32, v33, s[42:43]
    v_cndmask_b32 v137, v33, v32, s[42:43]
    v_cndmask_b32 v122, v32, v33, s[44:45]
    v_cndmask_b32 v138, v33, v32, s[44:45]
    v_cndmask_b32 v123, v32, v33, s[46:47]
    v_cndmask_b32 v139, v33, v32, s[46:47]
    v_cmp_le_i32 s[40:41], 20, v7
    v_cmp_le_i32 s[42:43], 21, v7
    v_cmp_le_i32 s[44:45], 22, v7
    v_cmp_le_i32 s[46:47], 23, v7
    v_cndmask_b32 v124, v32, v33, s[40:41]
    v_cndmask_b32 v140, v33, v32, s[40:41]
    v_cndmask_b32 v125, v32, v33, s[42:43]
    v_cndmask_b32 v141, v33, v32, s[42:43]
    v_cndmask_b32 v126, v32, v33, s[44:45]
    v_cndmask_b32 v142, v33, v32, s[44:45]
    v_cndmask_b32 v127, v32, v33, s[46:47]
    v_cndmask_b32 v143, v33, v32, s[46:47]
    s_waitcnt vmcnt(0)
    s_barrier
    ds_read_b128 v[16:19], v3 offset:20480
    ds_read_b64 v[14:15], v4 offset:20480
    s_waitcnt lgkmcnt(0)
    v_mfma_f32_32x32x16_bf16 v[64:79], v[16:19], v[8:11], v[112:127]
    v_mfma_f32_32x32x8_bf16 v[64:79], v[14:15], v[12:13], v[64:79]
    v_mov_b32 v48, 0
    v_mov_b32 v49, 0
    v_mov_b32 v50, 0
    v_mov_b32 v51, 0
    v_mov_b32 v52, 0
    v_mov_b32 v53, 0
    v_mov_b32 v54, 0
    v_mov_b32 v55, 0
    v_mov_b32 v56, 0
    v_mov_b32 v57, 0
    v_mov_b32 v58, 0
    v_mov_b32 v59, 0
    v_mov_b32 v60, 0
    v_mov_b32 v61, 0
    v_mov_b32 v62, 0
    v_mov_b32 v63, 0
    v_mov_b32 v32, 0
    v_mov_b32 v33, 0
    v_mov_b32 v34, 0
    v_mov_b32 v35, 0
    v_mov_b32 v36, 0
    v_mov_b32 v37, 0
    v_mov_b32 v38, 0
    v_mov_b32 v39, 0
    v_max3_f32 v7, v64, v65, v66
    v_max_f32 v7, v7, v67
    v_max3_f32 v7, v7, v68, v69
    v_max3_f32 v7, v7, v70, v71
    v_max3_f32 v7, v7, v72, v73
    v_max3_f32 v7, v7, v74, v75
    v_max3_f32 v7, v7, v76, v77
    v_max3_f32 v7, v7, v78, v79
attA_have_m:
    ds_read_b128 v[16:19], v3 offset:17920
    ds_read_b64 v[14:15], v4 offset:17920
    s_mov_b64 exec, s[32:33]
    ds_read_b128 v[20:23], v5 offset:20480
    ds_read_b128 v[24:27], v5 offset:21120
    s_mov_b64 exec, -1
    v_mov_b32 v40, v7
    s_nop 1
    v_permlane32_swap_b32 v40, v7
    v_max_f32 v7, v7, v40
    v_sub_f32 v7, 0, v7
    v_mov_b32 v96, v7
    v_mov_b32 v97, v7
    v_mov_b32 v98, v7
    v_mov_b32 v99, v7
    v_mov_b32 v100, v7
    v_mov_b32 v101, v7
    v_mov_b32 v102, v7
    v_mov_b32 v103, v7
    v_mov_b32 v104, v7
    v_mov_b32 v105, v7
    v_mov_b32 v106, v7
    v_mov_b32 v107, v7
    v_mov_b32 v108, v7
    v_mov_b32 v109, v7
    v_mov_b32 v110, v7
    v_mov_b32 v111, v7
    v_add_f32 v64, v7, v64
    v_add_f32 v65, v7, v65
    v_add_f32 v66, v7, v66
    v_add_f32 v67, v7, v67
    v_add_f32 v68, v7, v68
    v_add_f32 v69, v7, v69
    v_add_f32 v70, v7, v70
    v_add_f32 v71, v7, v71
    v_add_f32 v72, v7, v72
    v_add_f32 v73, v7, v73
    v_add_f32 v74, v7, v74
    v_add_f32 v75, v7, v75
    v_add_f32 v76, v7, v76
    v_add_f32 v77, v7, v77
    v_add_f32 v78, v7, v78
    v_add_f32 v79, v7, v79
    v_add_f32 v128, v7, v128
    v_add_f32 v129, v7, v129
    v_add_f32 v130, v7, v130
    v_add_f32 v131, v7, v131
    v_add_f32 v132, v7, v132
    v_add_f32 v133, v7, v133
    v_add_f32 v134, v7, v134
    v_add_f32 v135, v7, v135
    v_add_f32 v136, v7, v136
    v_add_f32 v137, v7, v137
    v_add_f32 v138, v7, v138
    v_add_f32 v139, v7, v139
    v_add_f32 v140, v7, v140
    v_add_f32 v141, v7, v141
    v_add_f32 v142, v7, v142
    v_add_f32 v143, v7, v143
    s_cmp_eq_u32 s36, 1
    s_cbranch_scc1 attA_last0
    s_waitcnt lgkmcnt(2)
    v_mfma_f32_32x32x16_bf16 v[80:95], v[16:19], v[8:11], v[96:111]
    v_exp_f32 v64, v64
    v_exp_f32 v65, v65
    v_exp_f32 v66, v66
    v_exp_f32 v67, v67
    v_smfmac_f32_32x32x32_bf16 v[48:63], v[28:31], v[32:39], v47
    v_exp_f32 v68, v68
    v_exp_f32 v69, v69
    v_exp_f32 v70, v70
    v_exp_f32 v71, v71
    v_mfma_f32_32x32x8_bf16 v[80:95], v[14:15], v[12:13], v[80:95]
    ds_read_b128 v[16:19], v3 offset:15360
    ds_read_b64 v[14:15], v4 offset:15360
    v_exp_f32 v32, v72
    v_exp_f32 v33, v73
    v_exp_f32 v34, v74
    v_exp_f32 v35, v75
    s_waitcnt lgkmcnt(2)
    v_smfmac_f32_32x32x32_bf16 v[48:63], v[20:23], v[64:71], v47
    s_mov_b64 exec, s[32:33]
    ds_read_b128 v[20:23], v5 offset:17920
    ds_read_b128 v[28:31], v5 offset:18560
    s_mov_b64 exec, -1
    v_exp_f32 v36, v76
    v_exp_f32 v37, v77
    v_exp_f32 v38, v78
    v_exp_f32 v39, v79
    s_cmp_eq_u32 s36, 2
    s_cbranch_scc1 attA_last1
    s_waitcnt lgkmcnt(2)
    v_mfma_f32_32x32x16_bf16 v[64:79], v[16:19], v[8:11], v[96:111]
    v_exp_f32 v80, v80
    v_exp_f32 v81, v81
    v_exp_f32 v82, v82
    v_exp_f32 v83, v83
    v_smfmac_f32_32x32x32_bf16 v[48:63], v[24:27], v[32:39], v47
    v_exp_f32 v84, v84
    v_exp_f32 v85, v85
    v_exp_f32 v86, v86
    v_exp_f32 v87, v87
    v_mfma_f32_32x32x8_bf16 v[64:79], v[14:15], v[12:13], v[64:79]
    ds_read_b128 v[16:19], v3 offset:12800
    ds_read_b64 v[14:15], v4 offset:12800
    v_exp_f32 v32, v88
    v_exp_f32 v33, v89
    v_exp_f32 v34, v90
    v_exp_f32 v35, v91
    s_waitcnt lgkmcnt(2)
    v_smfmac_f32_32x32x32_bf16 v[48:63], v[20:23], v[80:87], v47
    s_mov_b64 exec, s[32:33]
    ds_read_b128 v[20:23], v5 offset:15360
    ds_read_b128 v[24:27], v5 offset:16000
    s_mov_b64 exec, -1
    v_exp_f32 v36, v92
    v_exp_f32 v37, v93
    v_exp_f32 v38, v94
    v_exp_f32 v39, v95
    s_cmp_eq_u32 s36, 3
    s_cbranch_scc1 attA_last0
    s_waitcnt lgkmcnt(2)
    v_mfma_f32_32x32x16_bf16 v[80:95], v[16:19], v[8:11], v[96:111]
    v_exp_f32 v64, v64
    v_exp_f32 v65, v65
    v_exp_f32 v66, v66
    v_exp_f32 v67, v67
    v_smfmac_f32_32x32x32_bf16 v[48:63], v[28:31], v[32:39], v47
    v_exp_f32 v68, v68
    v_exp_f32 v69, v69
    v_exp_f32 v70, v70
    v_exp_f32 v71, v71
    v_mfma_f32_32x32x8_bf16 v[80:95], v[14:15], v[12:13], v[80:95]
    ds_read_b128 v[16:19], v3 offset:10240
    ds_read_b64 v[14:15], v4 offset:10240
    v_exp_f32 v32, v72
    v_exp_f32 v33, v73
    v_exp_f32 v34, v74
    v_exp_f32 v35, v75
    s_waitcnt lgkmcnt(2)
    v_smfmac_f32_32x32x32_bf16 v[48:63], v[20:23], v[64:71], v47
    s_mov_b64 exec, s[32:33]
    ds_read_b128 v[20:23], v5 offset:12800
    ds_read_b128 v[28:31], v5 offset:13440
    s_mov_b64 exec, -1
    v_exp_f32 v36, v76
    v_exp_f32 v37, v77
    v_exp_f32 v38, v78
    v_exp_f32 v39, v79
    s_cmp_eq_u32 s36, 4
    s_cbranch_scc1 attA_last1
    s_waitcnt lgkmcnt(2)
    v_mfma_f32_32x32x16_bf16 v[64:79], v[16:19], v[8:11], v[96:111]
    v_exp_f32 v80, v80
    v_exp_f32 v81, v81
    v_exp_f32 v82, v82
    v_exp_f32 v83, v83
    v_smfmac_f32_32x32x32_bf16 v[48:63], v[24:27], v[32:39], v47
    v_exp_f32 v84, v84
    v_exp_f32 v85, v85
    v_exp_f32 v86, v86
    v_exp_f32 v87, v87
    v_mfma_f32_32x32x8_bf16 v[64:79], v[14:15], v[12:13], v[64:79]
    ds_read_b128 v[16:19], v3 offset:7680
    ds_read_b64 v[14:15], v4 offset:7680
    v_exp_f32 v32, v88
    v_exp_f32 v33, v89
    v_exp_f32 v34, v90
    v_exp_f32 v35, v91
    s_waitcnt lgkmcnt(2)
    v_smfmac_f32_32x32x32_bf16 v[48:63], v[20:23], v[80:87], v47
    s_mov_b64 exec, s[32:33]
    ds_read_b128 v[20:23], v5 offset:10240
    ds_read_b128 v[24:27], v5 offset:10880
    s_mov_b64 exec, -1
    v_exp_f32 v36, v92
    v_exp_f32 v37, v93
    v_exp_f32 v38, v94
    v_exp_f32 v39, v95
    s_cmp_eq_u32 s36, 5
    s_cbranch_scc1 attA_last0
    s_waitcnt lgkmcnt(2)
    v_mfma_f32_32x32x16_bf16 v[80:95], v[16:19], v[8:11], v[96:111]
    v_exp_f32 v64, v64
    v_exp_f32 v65, v65
    v_exp_f32 v66, v66
    v_exp_f32 v67, v67
    v_smfmac_f32_32x32x32_bf16 v[48:63], v[28:31], v[32:39], v47
    v_exp_f32 v68, v68
    v_exp_f32 v69, v69
    v_exp_f32 v70, v70
    v_exp_f32 v71, v71
    v_mfma_f32_32x32x8_bf16 v[80:95], v[14:15], v[12:13], v[80:95]
    ds_read_b128 v[16:19], v3 offset:5120
    ds_read_b64 v[14:15], v4 offset:5120
    v_exp_f32 v32, v72
    v_exp_f32 v33, v73
    v_exp_f32 v34, v74
    v_exp_f32 v35, v75
    s_waitcnt lgkmcnt(2)
    v_smfmac_f32_32x32x32_bf16 v[48:63], v[20:23], v[64:71], v47
    s_mov_b64 exec, s[32:33]
    ds_read_b128 v[20:23], v5 offset:7680
    ds_read_b128 v[28:31], v5 offset:8320
    s_mov_b64 exec, -1
    v_exp_f32 v36, v76
    v_exp_f32 v37, v77
    v_exp_f32 v38, v78
    v_exp_f32 v39, v79
    s_cmp_eq_u32 s36, 6
    s_cbranch_scc1 attA_last1
    s_waitcnt lgkmcnt(2)
    v_mfma_f32_32x32x16_bf16 v[64:79], v[16:19], v[8:11], v[96:111]
    v_exp_f32 v80, v80
    v_exp_f32 v81, v81
    v_exp_f32 v82, v82
    v_exp_f32 v83, v83
    v_smfmac_f32_32x32x32_bf16 v[48:63], v[24:27], v[32:39], v47
    v_exp_f32 v84, v84
    v_exp_f32 v85, v85
    v_exp_f32 v86, v86
    v_exp_f32 v87, v87
    v_mfma_f32_32x32x8_bf16 v[64:79], v[14:15], v[12:13], v[64:79]
    ds_read_b128 v[16:19], v3 offset:2560
    ds_read_b64 v[14:15], v4 offset:2560
    v_exp_f32 v32, v88
    v_exp_f32 v33, v89
    v_exp_f32 v34, v90
    v_exp_f32 v35, v91
    s_waitcnt lgkmcnt(2)
    v_smfmac_f32_32x32x32_bf16 v[48:63], v[20:23], v[80:87], v47
    s_mov_b64 exec, s[32:33]
    ds_read_b128 v[20:23], v5 offset:5120
    ds_read_b128 v[24:27], v5 offset:5760
    s_mov_b64 exec, -1
    v_exp_f32 v36, v92
    v_exp_f32 v37, v93
    v_exp_f32 v38, v94
    v_exp_f32 v39, v95
    s_cmp_eq_u32 s36, 7
    s_cbranch_scc1 attA_last0
    s_waitcnt lgkmcnt(2)
    v_mfma_f32_32x32x16_bf16 v[80:95], v[16:19], v[8:11], v[96:111]
    v_exp_f32 v64, v64
    v_exp_f32 v65, v65
    v_exp_f32 v66, v66
    v_exp_f32 v67, v67
    v_smfmac_f32_32x32x32_bf16 v[48:63], v[28:31], v[32:39], v47
    v_exp_f32 v68, v68
    v_exp_f32 v69, v69
    v_exp_f32 v70, v70
    v_exp_f32 v71, v71
    v_mfma_f32_32x32x8_bf16 v[80:95], v[14:15], v[12:13], v[80:95]
    ds_read_b128 v[16:19], v3 offset:0
    ds_read_b64 v[14:15], v4 offset:0
    v_exp_f32 v32, v72
    v_exp_f32 v33, v73
    v_exp_f32 v34, v74
    v_exp_f32 v35, v75
    s_waitcnt lgkmcnt(2)
    v_smfmac_f32_32x32x32_bf16 v[48:63], v[20:23], v[64:71], v47
    s_mov_b64 exec, s[32:33]
    ds_read_b128 v[20:23], v5 offset:2560
    ds_read_b128 v[28:31], v5 offset:3200
    s_mov_b64 exec, -1
    v_exp_f32 v36, v76
    v_exp_f32 v37, v77
    v_exp_f32 v38, v78
    v_exp_f32 v39, v79
    s_cmp_eq_u32 s36, 8
    s_cbranch_scc1 attA_last1
    s_cmp_eq_u32 s49, 7
    s_cbranch_scc0 attA_noprio
    s_setprio 0
attA_noprio:
    s_waitcnt lgkmcnt(2)
    v_mfma_f32_32x32x16_bf16 v[64:79], v[16:19], v[8:11], v[128:143]
    v_exp_f32 v80, v80
    v_exp_f32 v81, v81
    v_exp_f32 v82, v82
    v_exp_f32 v83, v83
    v_smfmac_f32_32x32x32_bf16 v[48:63], v[24:27], v[32:39], v47
    v_exp_f32 v84, v84
    v_exp_f32 v85, v85
    v_exp_f32 v86, v86
    v_exp_f32 v87, v87
    v_mfma_f32_32x32x8_bf16 v[64:79], v[14:15], v[12:13], v[64:79]
    v_exp_f32 v32, v88
    v_exp_f32 v33, v89
    v_exp_f32 v34, v90
    v_exp_f32 v35, v91
    s_waitcnt lgkmcnt(0)
    v_smfmac_f32_32x32x32_bf16 v[48:63], v[20:23], v[80:87], v47
    s_mov_b64 exec, s[32:33]
    ds_read_b128 v[20:23], v5 offset:0
    ds_read_b128 v[24:27], v5 offset:640
    s_mov_b64 exec, -1
    v_exp_f32 v36, v92
    v_exp_f32 v37, v93
    v_exp_f32 v38, v94
    v_exp_f32 v39, v95
attA_last0:
    v_exp_f32 v64, v64
    v_exp_f32 v65, v65
    v_exp_f32 v66, v66
    v_exp_f32 v67, v67
    v_smfmac_f32_32x32x32_bf16 v[48:63], v[28:31], v[32:39], v47
    v_exp_f32 v68, v68
    v_exp_f32 v69, v69
    v_exp_f32 v70, v70
    v_exp_f32 v71, v71
    v_exp_f32 v32, v72
    v_exp_f32 v33, v73
    v_exp_f32 v34, v74
    v_exp_f32 v35, v75
    s_waitcnt lgkmcnt(0)
    v_smfmac_f32_32x32x32_bf16 v[48:63], v[20:23], v[64:71], v47
    v_exp_f32 v36, v76
    v_exp_f32 v37, v77
    v_exp_f32 v38, v78
    v_exp_f32 v39, v79
    s_nop 1
    v_smfmac_f32_32x32x32_bf16 v[48:63], v[24:27], v[32:39], v47
attA_fin:
    s_waitcnt lgkmcnt(0)
    s_nop 10
    v_mov_b32 v40, v56
    v_mov_b32 v41, v56
    s_nop 1
    v_permlane32_swap_b32 v40, v41
    v_mul_f32 v42, 0x5f800000, v41
    v_mul_f32 v42, 0, v42
    v_fmac_f32 v42, 0, v48
    v_fmac_f32 v42, 0, v49
    v_fmac_f32 v42, 0, v50
    v_fmac_f32 v42, 0, v51
    v_fmac_f32 v42, 0, v52
    v_fmac_f32 v42, 0, v53
    v_fmac_f32 v42, 0, v54
    v_fmac_f32 v42, 0, v55
    v_fmac_f32 v42, 0, v56
    v_fmac_f32 v42, 0, v57
    v_fmac_f32 v42, 0, v58
    v_fmac_f32 v42, 0, v59
    v_rcp_f32 v41, v41
    v_cmp_u_f32 vcc, v42, v42
    s_cmp_eq_u32 s48, 0
    s_nop 0
    s_cselect_b64 s[40:41], vcc, 0
    s_cmp_lg_u64 s[40:41], 0
    s_cbranch_scc1 attA_slow
    v_mul_f32 v48, v41, v48
    v_mul_f32 v49, v41, v49
    v_mul_f32 v50, v41, v50
    v_mul_f32 v51, v41, v51
    v_mul_f32 v52, v41, v52
    v_mul_f32 v53, v41, v53
    v_mul_f32 v54, v41, v54
    v_mul_f32 v55, v41, v55
    v_mul_f32 v56, v41, v56
    v_mul_f32 v57, v41, v57
    v_mul_f32 v58, v41, v58
    v_mul_f32 v59, v41, v59
    v_cvt_pk_bf16_f32 v32, v48, v49
    v_cvt_pk_bf16_f32 v33, v50, v51
    v_cvt_pk_bf16_f32 v34, v52, v53
    v_cvt_pk_bf16_f32 v35, v54, v55
    v_cvt_pk_bf16_f32 v36, v56, v57
    v_cvt_pk_bf16_f32 v37, v58, v59
    buffer_store_dwordx2 v[32:33], v6, s[24:27], s39 offen sc0 sc1
    buffer_store_dwordx2 v[34:35], v6, s[24:27], s34 offen sc0 sc1
    s_mov_b32 exec_hi, 0
    buffer_store_dwordx2 v[36:37], v46, s[24:27], s35 offen sc0 sc1
    s_branch opq_entry
attA_slow:
    s_mov_b32 s48, 1
    v_mov_b32 v7, 0xf149f2ca
    v_mov_b32 v48, 0
    v_mov_b32 v49, 0
    v_mov_b32 v50, 0
    v_mov_b32 v51, 0
    v_mov_b32 v52, 0
    v_mov_b32 v53, 0
    v_mov_b32 v54, 0
    v_mov_b32 v55, 0
    v_mov_b32 v56, 0
    v_mov_b32 v57, 0
    v_mov_b32 v58, 0
    v_mov_b32 v59, 0
    v_mov_b32 v60, 0
    v_mov_b32 v61, 0
    v_mov_b32 v62, 0
    v_mov_b32 v63, 0
    v_mov_b32 v32, 0
    v_mov_b32 v33, 0
    v_mov_b32 v34, 0
    v_mov_b32 v35, 0
    v_mov_b32 v36, 0
    v_mov_b32 v37, 0
    v_mov_b32 v38, 0
    v_mov_b32 v39, 0
    v_sub_f32 v128, 0xf149f2ca, v112
    v_sub_f32 v129, 0xf149f2ca, v113
    v_sub_f32 v130, 0xf149f2ca, v114
    v_sub_f32 v131, 0xf149f2ca, v115
    v_sub_f32 v132, 0xf149f2ca, v116
    v_sub_f32 v133, 0xf149f2ca, v117
    v_sub_f32 v134, 0xf149f2ca, v118
    v_sub_f32 v135, 0xf149f2ca, v119
    v_sub_f32 v136, 0xf149f2ca, v120
    v_sub_f32 v137, 0xf149f2ca, v121
    v_sub_f32 v138, 0xf149f2ca, v122
    v_sub_f32 v139, 0xf149f2ca, v123
    v_sub_f32 v140, 0xf149f2ca, v124
    v_sub_f32 v141, 0xf149f2ca, v125
    v_sub_f32 v142, 0xf149f2ca, v126
    v_sub_f32 v143, 0xf149f2ca, v127
    s_cmp_ge_u32 8, s36
    s_cbranch_scc1 attA_sskip8
    ds_read_b128 v[16:19], v3 offset:0
    ds_read_b64 v[14:15], v4 offset:0
    s_waitcnt lgkmcnt(0)
    v_mfma_f32_32x32x16_bf16 v[64:79], v[16:19], v[8:11], v[128:143]
    v_mfma_f32_32x32x8_bf16 v[64:79], v[14:15], v[12:13], v[64:79]
    s_nop 11
    v_max3_f32 v7, v7, v64, v65
    v_max3_f32 v7, v7, v66, v67
    v_max3_f32 v7, v7, v68, v69
    v_max3_f32 v7, v7, v70, v71
    v_max3_f32 v7, v7, v72, v73
    v_max3_f32 v7, v7, v74, v75
    v_max3_f32 v7, v7, v76, v77
    v_max3_f32 v7, v7, v78, v79
attA_sskip8:
    s_cmp_ge_u32 7, s36
    s_cbranch_scc1 attA_sskip7
    ds_read_b128 v[16:19], v3 offset:2560
    ds_read_b64 v[14:15], v4 offset:2560
    s_waitcnt lgkmcnt(0)
    v_mfma_f32_32x32x16_bf16 v[64:79], v[16:19], v[8:11], 0
    v_mfma_f32_32x32x8_bf16 v[64:79], v[14:15], v[12:13], v[64:79]
    s_nop 11
    v_max3_f32 v7, v7, v64, v65
    v_max3_f32 v7, v7, v66, v67
    v_max3_f32 v7, v7, v68, v69
    v_max3_f32 v7, v7, v70, v71
    v_max3_f32 v7, v7, v72, v73
    v_max3_f32 v7, v7, v74, v75
    v_max3_f32 v7, v7, v76, v77
    v_max3_f32 v7, v7, v78, v79
attA_sskip7:
    s_cmp_ge_u32 6, s36
    s_cbranch_scc1 attA_sskip6
    ds_read_b128 v[16:19], v3 offset:5120
    ds_read_b64 v[14:15], v4 offset:5120
    s_waitcnt lgkmcnt(0)
    v_mfma_f32_32x32x16_bf16 v[64:79], v[16:19], v[8:11], 0
    v_mfma_f32_32x32x8_bf16 v[64:79], v[14:15], v[12:13], v[64:79]
    s_nop 11
    v_max3_f32 v7, v7, v64, v65
    v_max3_f32 v7, v7, v66, v67
    v_max3_f32 v7, v7, v68, v69
    v_max3_f32 v7, v7, v70, v71
    v_max3_f32 v7, v7, v72, v73
    v_max3_f32 v7, v7, v74, v75
    v_max3_f32 v7, v7, v76, v77
    v_max3_f32 v7, v7, v78, v79
attA_sskip6:
    s_cmp_ge_u32 5, s36
    s_cbranch_scc1 attA_sskip5
    ds_read_b128 v[16:19], v3 offset:7680
    ds_read_b64 v[14:15], v4 offset:7680
    s_waitcnt lgkmcnt(0)
    v_mfma_f32_32x32x16_bf16 v[64:79], v[16:19], v[8:11], 0
    v_mfma_f32_32x32x8_bf16 v[64:79], v[14:15], v[12:13], v[64:79]
    s_nop 11
    v_max3_f32 v7, v7, v64, v65
    v_max3_f32 v7, v7, v66, v67
    v_max3_f32 v7, v7, v68, v69
    v_max3_f32 v7, v7, v70, v71
    v_max3_f32 v7, v7, v72, v73
    v_max3_f32 v7, v7, v74, v75
    v_max3_f32 v7, v7, v76, v77
    v_max3_f32 v7, v7, v78, v79
attA_sskip5:
    s_cmp_ge_u32 4, s36
    s_cbranch_scc1 attA_sskip4
    ds_read_b128 v[16:19], v3 offset:10240
    ds_read_b64 v[14:15], v4 offset:10240
    s_waitcnt lgkmcnt(0)
    v_mfma_f32_32x32x16_bf16 v[64:79], v[16:19], v[8:11], 0
    v_mfma_f32_32x32x8_bf16 v[64:79], v[14:15], v[12:13], v[64:79]
    s_nop 11
    v_max3_f32 v7, v7, v64, v65
    v_max3_f32 v7, v7, v66, v67
    v_max3_f32 v7, v7, v68, v69
    v_max3_f32 v7, v7, v70, v71
    v_max3_f32 v7, v7, v72, v73
    v_max3_f32 v7, v7, v74, v75
    v_max3_f32 v7, v7, v76, v77
    v_max3_f32 v7, v7, v78, v79
attA_sskip4:
    s_cmp_ge_u32 3, s36
    s_cbranch_scc1 attA_sskip3
    ds_read_b128 v[16:19], v3 offset:12800
    ds_read_b64 v[14:15], v4 offset:12800
    s_waitcnt lgkmcnt(0)
    v_mfma_f32_32x32x16_bf16 v[64:79], v[16:19], v[8:11], 0
    v_mfma_f32_32x32x8_bf16 v[64:79], v[14:15], v[12:13], v[64:79]
    s_nop 11
    v_max3_f32 v7, v7, v64, v65
    v_max3_f32 v7, v7, v66, v67
    v_max3_f32 v7, v7, v68, v69
    v_max3_f32 v7, v7, v70, v71
    v_max3_f32 v7, v7, v72, v73
    v_max3_f32 v7, v7, v74, v75
    v_max3_f32 v7, v7, v76, v77
    v_max3_f32 v7, v7, v78, v79
attA_sskip3:
    s_cmp_ge_u32 2, s36
    s_cbranch_scc1 attA_sskip2
    ds_read_b128 v[16:19], v3 offset:15360
    ds_read_b64 v[14:15], v4 offset:15360
    s_waitcnt lgkmcnt(0)
    v_mfma_f32_32x32x16_bf16 v[64:79], v[16:19], v[8:11], 0
    v_mfma_f32_32x32x8_bf16 v[64:79], v[14:15], v[12:13], v[64:79]
    s_nop 11
    v_max3_f32 v7, v7, v64, v65
    v_max3_f32 v7, v7, v66, v67
    v_max3_f32 v7, v7, v68, v69
    v_max3_f32 v7, v7, v70, v71
    v_max3_f32 v7, v7, v72, v73
    v_max3_f32 v7, v7, v74, v75
    v_max3_f32 v7, v7, v76, v77
    v_max3_f32 v7, v7, v78, v79
attA_sskip2:
    s_cmp_ge_u32 1, s36
    s_cbranch_scc1 attA_sskip1
    ds_read_b128 v[16:19], v3 offset:17920
    ds_read_b64 v[14:15], v4 offset:17920
    s_waitcnt lgkmcnt(0)
    v_mfma_f32_32x32x16_bf16 v[64:79], v[16:19], v[8:11], 0
    v_mfma_f32_32x32x8_bf16 v[64:79], v[14:15], v[12:13], v[64:79]
    s_nop 11
    v_max3_f32 v7, v7, v64, v65
    v_max3_f32 v7, v7, v66, v67
    v_max3_f32 v7, v7, v68, v69
    v_max3_f32 v7, v7, v70, v71
    v_max3_f32 v7, v7, v72, v73
    v_max3_f32 v7, v7, v74, v75
    v_max3_f32 v7, v7, v76, v77
    v_max3_f32 v7, v7, v78, v79
attA_sskip1:
    ds_read_b128 v[16:19], v3 offset:20480
    ds_read_b64 v[14:15], v4 offset:20480
    s_waitcnt lgkmcnt(0)
    v_mfma_f32_32x32x16_bf16 v[64:79], v[16:19], v[8:11], v[112:127]
    v_mfma_f32_32x32x8_bf16 v[64:79], v[14:15], v[12:13], v[64:79]
    s_nop 11
    v_max3_f32 v7, v7, v64, v65
    v_max3_f32 v7, v7, v66, v67
    v_max3_f32 v7, v7, v68, v69
    v_max3_f32 v7, v7, v70, v71
    v_max3_f32 v7, v7, v72, v73
    v_max3_f32 v7, v7, v74, v75
    v_max3_f32 v7, v7, v76, v77
    v_max3_f32 v7, v7, v78, v79
    s_branch attA_have_m
attA_last1:
    v_exp_f32 v80, v80
    v_exp_f32 v81, v81
    v_exp_f32 v82, v82
    v_exp_f32 v83, v83
    v_smfmac_f32_32x32x32_bf16 v[48:63], v[24:27], v[32:39], v47
    v_exp_f32 v84, v84
    v_exp_f32 v85, v85
    v_exp_f32 v86, v86
    v_exp_f32 v87, v87
    v_exp_f32 v32, v88
    v_exp_f32 v33, v89
    v_exp_f32 v34, v90
    v_exp_f32 v35, v91
    s_waitcnt lgkmcnt(0)
    v_smfmac_f32_32x32x32_bf16 v[48:63], v[20:23], v[80:87], v47
    v_exp_f32 v36, v92
    v_exp_f32 v37, v93
    v_exp_f32 v38, v94
    v_exp_f32 v39, v95
    s_nop 1
    v_smfmac_f32_32x32x32_bf16 v[48:63], v[28:31], v[32:39], v47
    s_branch attA_fin
.globl fus3_kernel
.p2align 8
.type fus3_kernel,@function
fus3_kernel:
    s_load_dwordx2 s[4:5], s[0:1], 64
    s_load_dwordx2 s[52:53], s[0:1], 48
    s_mov_b32 s10, 50331648
    s_mov_b32 s54, 2
    s_mov_b32 s57, 15269888
    s_mov_b32 s58, 0
    s_branch attB_body
.globl fus1_kernel
.p2align 8
.type fus1_kernel,@function
fus1_kernel:
    s_load_dwordx2 s[4:5], s[0:1], 64
    s_load_dwordx2 s[52:53], s[0:1], 64
    s_mov_b32 s10, 16777216
    s_mov_b32 s54, 0
    s_mov_b32 s57, 15138816
    s_mov_b32 s58, 33554432
attB_body:
    s_mov_b32 s55, 14155776
    s_mov_b32 s56, 13238272
    s_mov_b32 s59, 1
    s_load_dwordx2 s[8:9], s[0:1], 64
    s_load_dwordx2 s[6:7], s[0:1], 8
    s_cmp_ge_u32 s2, 256
    s_cbranch_scc1 attB_end
    s_and_b32 s11, s2, 7
    s_lshl_b32 s11, s11, 2
    s_lshr_b32 s28, s2, 3
    s_and_b32 s28, s28, 3
    s_add_u32 s11, s11, s28
    s_lshr_b32 s12, s2, 5
    v_lshrrev_b32 v1, 6, v0
    v_and_b32 v0, 63, v0
    v_readfirstlane_b32 s13, v1
    s_mul_i32 s28, s11, 163840
    s_add_u32 s28, s28, 7864320
    s_add_u32 s28, s28, s10
    s_mov_b32 s18, 163840
    s_mov_b32 s19, 0x20000
    v_lshlrev_b32 v3, 4, v0
    s_mul_i32 s30, s13, 2048
    s_waitcnt lgkmcnt(0)
    s_add_u32 s16, s8, s28
    s_addc_u32 s17, s9, 0
    s_cmp_eq_u32 s13, 8
    s_cbranch_scc0 attB_comp
    s_mov_b32 s31, 5
attB_ld0:
    s_mov_b32 m0, s30
    s_sub_u32 s31, s31, 1
    buffer_load_dwordx4 v3, s[16:19], s30 offen offset:0 lds
    buffer_load_dwordx4 v3, s[16:19], s30 offen offset:1024 lds
    buffer_load_dwordx4 v3, s[16:19], s30 offen offset:2048 lds
    buffer_load_dwordx4 v3, s[16:19], s30 offen offset:3072 lds
    s_add_u32 s30, s30, 4096
    s_cmp_lg_u32 s31, 0
    s_cbranch_scc1 attB_ld0
    s_barrier
    s_mov_b32 s31, 21
attB_ld1:
    s_waitcnt vmcnt(59)
    s_mov_b32 m0, s30
    s_sub_u32 s31, s31, 1
    buffer_load_dwordx4 v3, s[16:19], s30 offen offset:0 lds
    buffer_load_dwordx4 v3, s[16:19], s30 offen offset:1024 lds
    buffer_load_dwordx4 v3, s[16:19], s30 offen offset:2048 lds
    buffer_load_dwordx4 v3, s[16:19], s30 offen offset:3072 lds
    s_add_u32 s30, s30, 4096
    s_cmp_lg_u32 s31, 0
    s_cbranch_scc1 attB_ld1
    s_waitcnt vmcnt(60)
    s_barrier
    s_mov_b32 s31, 10
attB_ld2:
    s_waitcnt vmcnt(59)
    s_mov_b32 m0, s30
    s_sub_u32 s31, s31, 1
    buffer_load_dwordx4 v3, s[16:19], s30 offen offset:0 lds
    buffer_load_dwordx4 v3, s[16:19], s30 offen offset:1024 lds
    buffer_load_dwordx4 v3, s[16:19], s30 offen offset:2048 lds
    buffer_load_dwordx4 v3, s[16:19], s30 offen offset:3072 lds
    s_add_u32 s30, s30, 4096
    s_cmp_lg_u32 s31, 0
    s_cbranch_scc1 attB_ld2
    s_waitcnt vmcnt(0)
    s_add_u32 s20, s8, 14155776
    s_addc_u32 s21, s9, 0
    s_mov_b32 s22, 819200
    s_mov_b32 s23, 0x20000
    s_mov_b32 s24, s6
    s_mov_b32 s25, s7
    s_mov_b32 s26, 2457600
    s_mov_b32 s27, 0x20000
    s_lshr_b32 s28, s2, 3
    v_lshlrev_b32 v8, 7, v0
    s_lshl_b32 s29, s28, 15
    s_add_u32 s33, s29, 0
    buffer_load_dword v10, v8, s[20:23], s33 offen
    s_add_u32 s33, s29, 8192
    buffer_load_dword v11, v8, s[20:23], s33 offen
    s_add_u32 s33, s29, 16384
    buffer_load_dword v12, v8, s[20:23], s33 offen
    s_add_u32 s33, s29, 24576
    buffer_load_dword v13, v8, s[20:23], s33 offen
    v_lshrrev_b32 v8, 4, v0
    v_mul_u32_u24 v8, 3840, v8
    v_and_b32 v9, 15, v0
    v_lshl_add_u32 v8, v9, 7, v8
    s_mul_i32 s29, s28, 76800
    s_and_b32 s33, s2, 1
    s_lshl_b32 s33, s33, 11
    s_add_u32 s29, s29, s33
    s_add_u32 s33, s29, 0
    buffer_load_dword v16, v8, s[24:27], s33 offen
    s_add_u32 s33, s29, 15360
    buffer_load_dword v17, v8, s[24:27], s33 offen
    s_add_u32 s33, s29, 30720
    buffer_load_dword v18, v8, s[24:27], s33 offen
    s_add_u32 s33, s29, 46080
    buffer_load_dword v19, v8, s[24:27], s33 offen
    s_add_u32 s33, s29, 61440
    buffer_load_dword v20, v8, s[24:27], s33 offen
    s_barrier
    s_barrier
    s_barrier
    s_barrier
    s_branch opq_w8
attB_end:
    s_endpgm
attB_comp:
    s_add_u32 m0, s30, 0
    s_mul_i32 s28, s11, 81920
    buffer_load_dwordx4 v3, s[16:19], s30 offen offset:0 lds
    buffer_load_dwordx4 v3, s[16:19], s30 offen offset:1024 lds
    s_mul_i32 s29, s12, 10240
    s_add_u32 s28, s28, s29
    s_mul_i32 s29, s13, 1280
    s_add_u32 s28, s28, s29
    s_add_u32 s28, s28, 5242880
    s_add_u32 s28, s28, s10
    s_mov_b32 s22, 1280
    s_mov_b32 s23, 0x20000
    v_lshlrev_b32 v7, 3, v0
    v_add_u32 v7, 1024, v7
    s_add_u32 s20, s8, s28
    s_addc_u32 s21, s9, 0
    buffer_load_dwordx4 v[8:11], v3, s[20:23], 0 offen
    buffer_load_dwordx2 v[12:13], v7, s[20:23], 0 offen

    s_add_u32 s29, s10, 2621440
    s_mov_b32 s26, 2621440
    s_mov_b32 s27, 0x20000
    s_add_u32 s24, s8, s29
    s_addc_u32 s25, s9, 0
    v_lshrrev_b32 v1, 5, v0
    v_and_b32 v2, 31, v0
    v_and_b32 v7, 0x33, v0
    v_and_b32 v5, 4, v0
    v_lshl_add_u32 v7, v5, 1, v7
    v_and_b32 v5, 8, v0
    v_lshrrev_b32 v5, 1, v5
    v_add_u32 v7, v5, v7
    v_lshlrev_b32 v3, 4, v7
    v_and_b32 v7, 31, v7
    v_lshlrev_b32 v4, 3, v7
    v_add_u32 v4, 2304, v4
    v_mul_u32_u24 v5, 320, v1
    v_lshl_add_u32 v5, v2, 4, v5
    v_add_u32 v5, 1024, v5
    s_lshl_b32 s28, s12, 8
    s_lshl_b32 s29, s13, 5
    s_add_u32 s28, s28, s29
    v_add_u32 v46, s28, v2
    v_lshlrev_b32 v46, 3, v46
    v_lshlrev_b32 v6, 3, v1
    v_lshl_add_u32 v6, v46, 1, v6
    s_mov_b32 s32, 0x000fffff
    s_mov_b32 s33, 0x000fffff
    s_lshl_b32 s39, s11, 16
    s_add_u32 s34, s39, 32768
    s_lshl_b32 s35, s11, 14
    s_add_u32 s35, s35, 2097152
    s_mov_b32 s48, 0
    v_mov_b32 v47, 0xdddddddd
    s_mov_b32 s49, 99
    s_cmp_lt_u32 s13, 4
    s_cmov_b32 s49, 13
    s_setprio 1
    s_cbranch_scc0 attB_prio
    s_setprio 2
attB_prio:
    v_cmp_eq_u32 s[40:41], 20, v2
    v_mov_b32 v32, 0
    v_mov_b32 v33, 0x3f803f80
    v_cndmask_b32 v20, v32, v33, s[40:41]
    v_cndmask_b32 v21, v32, v33, s[40:41]
    v_cndmask_b32 v22, v32, v33, s[40:41]
    v_cndmask_b32 v23, v32, v33, s[40:41]
    v_cndmask_b32 v24, v32, v33, s[40:41]
    v_cndmask_b32 v25, v32, v33, s[40:41]
    v_cndmask_b32 v26, v32, v33, s[40:41]
    v_cndmask_b32 v27, v32, v33, s[40:41]
    v_cndmask_b32 v28, v32, v33, s[40:41]
    v_cndmask_b32 v29, v32, v33, s[40:41]
    v_cndmask_b32 v30, v32, v33, s[40:41]
    v_cndmask_b32 v31, v32, v33, s[40:41]
    s_mov_b32 s36, 1
    s_mov_b32 s37, 5
    s_waitcnt vmcnt(0)
    s_barrier
    ds_read_b128 v[16:19], v3 offset:0
    ds_read_b64 v[14:15], v4 offset:0
    s_waitcnt lgkmcnt(0)
    v_mfma_f32_32x32x16_bf16 v[64:79], v[16:19], v[8:11], 0
    v_mfma_f32_32x32x8_bf16 v[64:79], v[14:15], v[12:13], v[64:79]
    v_mov_b32 v48, 0
    v_mov_b32 v49, 0
    v_mov_b32 v50, 0
    v_mov_b32 v51, 0
    v_mov_b32 v52, 0
    v_mov_b32 v53, 0
    v_mov_b32 v54, 0
    v_mov_b32 v55, 0
    v_mov_b32 v56, 0
    v_mov_b32 v57, 0
    v_mov_b32 v58, 0
    v_mov_b32 v59, 0
    v_mov_b32 v60, 0
    v_mov_b32 v61, 0
    v_mov_b32 v62, 0
    v_mov_b32 v63, 0
    v_mov_b32 v32, 0
    v_mov_b32 v33, 0
    v_mov_b32 v34, 0
    v_mov_b32 v35, 0
    v_mov_b32 v36, 0
    v_mov_b32 v37, 0
    v_mov_b32 v38, 0
    v_mov_b32 v39, 0
    v_max3_f32 v7, v64, v65, v66
    v_max_f32 v7, v7, v67
    v_max3_f32 v7, v7, v68, v69
    v_max3_f32 v7, v7, v70, v71
    v_max3_f32 v7, v7, v72, v73
    v_max3_f32 v7, v7, v74, v75
    v_max3_f32 v7, v7, v76, v77
    v_max3_f32 v7, v7, v78, v79
attB_have_m:
    ds_read_b128 v[16:19], v3 offset:2560
    ds_read_b64 v[14:15], v4 offset:2560
    s_mov_b64 exec, s[32:33]
    ds_read_b128 v[20:23], v5 offset:0
    ds_read_b128 v[24:27], v5 offset:640
    s_mov_b64 exec, -1
    v_mov_b32 v40, v7
    s_nop 1
    v_permlane32_swap_b32 v40, v7
    v_max_f32 v7, v7, v40
    v_sub_f32 v7, 0, v7
    v_mov_b32 v96, v7
    v_mov_b32 v97, v7
    v_mov_b32 v98, v7
    v_mov_b32 v99, v7
    v_mov_b32 v100, v7
    v_mov_b32 v101, v7
    v_mov_b32 v102, v7
    v_mov_b32 v103, v7
    v_mov_b32 v104, v7
    v_mov_b32 v105, v7
    v_mov_b32 v106, v7
    v_mov_b32 v107, v7
    v_mov_b32 v108, v7
    v_mov_b32 v109, v7
    v_mov_b32 v110, v7
    v_mov_b32 v111, v7
    v_add_f32 v64, v7, v64
    v_add_f32 v65, v7, v65
    v_add_f32 v66, v7, v66
    v_add_f32 v67, v7, v67
    v_add_f32 v68, v7, v68
    v_add_f32 v69, v7, v69
    v_add_f32 v70, v7, v70
    v_add_f32 v71, v7, v71
    v_add_f32 v72, v7, v72
    v_add_f32 v73, v7, v73
    v_add_f32 v74, v7, v74
    v_add_f32 v75, v7, v75
    v_add_f32 v76, v7, v76
    v_add_f32 v77, v7, v77
    v_add_f32 v78, v7, v78
    v_add_f32 v79, v7, v79
    s_mov_b32 s38, 0
attB_loop:
    s_cmp_eq_u32 s38, s49
    s_cbranch_scc0 attB_noprio
    s_setprio 0
attB_noprio:
    s_cmp_eq_u32 s38, s36
    s_cbranch_scc1 attB_bar
    s_cmp_eq_u32 s38, s37
    s_cbranch_scc0 attB_nobar
attB_bar:
    s_barrier
attB_nobar:
    s_waitcnt lgkmcnt(2)
    v_mfma_f32_32x32x16_bf16 v[80:95], v[16:19], v[8:11], v[96:111]
    v_exp_f32 v64, v64
    v_exp_f32 v65, v65
    v_exp_f32 v66, v66
    v_exp_f32 v67, v67
    v_smfmac_f32_32x32x32_bf16 v[48:63], v[28:31], v[32:39], v47
    v_exp_f32 v68, v68
    v_exp_f32 v69, v69
    v_exp_f32 v70, v70
    v_exp_f32 v71, v71
    v_mfma_f32_32x32x8_bf16 v[80:95], v[14:15], v[12:13], v[80:95]
    ds_read_b128 v[16:19], v3 offset:5120
    ds_read_b64 v[14:15], v4 offset:5120
    v_exp_f32 v32, v72
    v_exp_f32 v33, v73
    v_exp_f32 v34, v74
    v_exp_f32 v35, v75
    s_waitcnt lgkmcnt(2)
    v_smfmac_f32_32x32x32_bf16 v[48:63], v[20:23], v[64:71], v47
    s_mov_b64 exec, s[32:33]
    ds_read_b128 v[20:23], v5 offset:2560
    ds_read_b128 v[28:31], v5 offset:3200
    s_mov_b64 exec, -1
    v_exp_f32 v36, v76
    v_exp_f32 v37, v77
    v_exp_f32 v38, v78
    v_exp_f32 v39, v79
    s_waitcnt lgkmcnt(2)
    v_mfma_f32_32x32x16_bf16 v[64:79], v[16:19], v[8:11], v[96:111]
    v_exp_f32 v80, v80
    v_exp_f32 v81, v81
    v_exp_f32 v82, v82
    v_exp_f32 v83, v83
    v_smfmac_f32_32x32x32_bf16 v[48:63], v[24:27], v[32:39], v47
    v_exp_f32 v84, v84
    v_exp_f32 v85, v85
    v_exp_f32 v86, v86
    v_exp_f32 v87, v87
    v_mfma_f32_32x32x8_bf16 v[64:79], v[14:15], v[12:13], v[64:79]
    ds_read_b128 v[16:19], v3 offset:7680
    ds_read_b64 v[14:15], v4 offset:7680
    v_exp_f32 v32, v88
    v_exp_f32 v33, v89
    v_exp_f32 v34, v90
    v_exp_f32 v35, v91
    s_waitcnt lgkmcnt(2)
    v_smfmac_f32_32x32x32_bf16 v[48:63], v[20:23], v[80:87], v47
    s_mov_b64 exec, s[32:33]
    ds_read_b128 v[20:23], v5 offset:5120
    ds_read_b128 v[24:27], v5 offset:5760
    s_mov_b64 exec, -1
    v_exp_f32 v36, v92
    v_exp_f32 v37, v93
    v_exp_f32 v38, v94
    v_exp_f32 v39, v95
    s_waitcnt lgkmcnt(2)
    v_mfma_f32_32x32x16_bf16 v[80:95], v[16:19], v[8:11], v[96:111]
    v_exp_f32 v64, v64
    v_exp_f32 v65, v65
    v_exp_f32 v66, v66
    v_exp_f32 v67, v67
    v_smfmac_f32_32x32x32_bf16 v[48:63], v[28:31], v[32:39], v47
    v_exp_f32 v68, v68
    v_exp_f32 v69, v69
    v_exp_f32 v70, v70
    v_exp_f32 v71, v71
    v_mfma_f32_32x32x8_bf16 v[80:95], v[14:15], v[12:13], v[80:95]
    ds_read_b128 v[16:19], v3 offset:10240
    ds_read_b64 v[14:15], v4 offset:10240
    v_exp_f32 v32, v72
    v_exp_f32 v33, v73
    v_exp_f32 v34, v74
    v_exp_f32 v35, v75
    s_waitcnt lgkmcnt(2)
    v_smfmac_f32_32x32x32_bf16 v[48:63], v[20:23], v[64:71], v47
    s_mov_b64 exec, s[32:33]
    ds_read_b128 v[20:23], v5 offset:7680
    ds_read_b128 v[28:31], v5 offset:8320
    s_mov_b64 exec, -1
    v_exp_f32 v36, v76
    v_exp_f32 v37, v77
    v_exp_f32 v38, v78
    v_exp_f32 v39, v79
    s_waitcnt lgkmcnt(2)
    v_mfma_f32_32x32x16_bf16 v[64:79], v[16:19], v[8:11], v[96:111]
    v_exp_f32 v80, v80
    v_exp_f32 v81, v81
    v_exp_f32 v82, v82
    v_exp_f32 v83, v83
    v_smfmac_f32_32x32x32_bf16 v[48:63], v[24:27], v[32:39], v47
    v_exp_f32 v84, v84
    v_exp_f32 v85, v85
    v_exp_f32 v86, v86
    v_exp_f32 v87, v87
    v_mfma_f32_32x32x8_bf16 v[64:79], v[14:15], v[12:13], v[64:79]
    ds_read_b128 v[16:19], v3 offset:12800
    ds_read_b64 v[14:15], v4 offset:12800
    v_exp_f32 v32, v88
    v_exp_f32 v33, v89
    v_exp_f32 v34, v90
    v_exp_f32 v35, v91
    s_waitcnt lgkmcnt(2)
    v_smfmac_f32_32x32x32_bf16 v[48:63], v[20:23], v[80:87], v47
    s_mov_b64 exec, s[32:33]
    ds_read_b128 v[20:23], v5 offset:10240
    ds_read_b128 v[24:27], v5 offset:10880
    s_mov_b64 exec, -1
    v_exp_f32 v36, v92
    v_exp_f32 v37, v93
    v_exp_f32 v38, v94
    v_exp_f32 v39, v95
    v_add_u32 v3, 10240, v3
    v_add_u32 v4, 10240, v4
    v_add_u32 v5, 10240, v5
    s_add_u32 s38, s38, 1
    s_cmp_lt_u32 s38, 16
    s_cbranch_scc1 attB_loop
    v_smfmac_f32_32x32x32_bf16 v[48:63], v[28:31], v[32:39], v47
attB_fin:
    s_waitcnt lgkmcnt(0)
    s_nop 10
    v_mov_b32 v40, v56
    v_mov_b32 v41, v56
    s_nop 1
    v_permlane32_swap_b32 v40, v41
    v_mul_f32 v42, 0x5f800000, v41
    v_mul_f32 v42, 0, v42
    v_fmac_f32 v42, 0, v48
    v_fmac_f32 v42, 0, v49
    v_fmac_f32 v42, 0, v50
    v_fmac_f32 v42, 0, v51
    v_fmac_f32 v42, 0, v52
    v_fmac_f32 v42, 0, v53
    v_fmac_f32 v42, 0, v54
    v_fmac_f32 v42, 0, v55
    v_fmac_f32 v42, 0, v56
    v_fmac_f32 v42, 0, v57
    v_fmac_f32 v42, 0, v58
    v_fmac_f32 v42, 0, v59
    v_rcp_f32 v41, v41
    v_cmp_u_f32 vcc, v42, v42
    s_cmp_eq_u32 s48, 0
    s_nop 0
    s_cselect_b64 s[40:41], vcc, 0
    s_cmp_lg_u64 s[40:41], 0
    s_cbranch_scc1 attB_slow
    v_mul_f32 v48, v41, v48
    v_mul_f32 v49, v41, v49
    v_mul_f32 v50, v41, v50
    v_mul_f32 v51, v41, v51
    v_mul_f32 v52, v41, v52
    v_mul_f32 v53, v41, v53
    v_mul_f32 v54, v41, v54
    v_mul_f32 v55, v41, v55
    v_mul_f32 v56, v41, v56
    v_mul_f32 v57, v41, v57
    v_mul_f32 v58, v41, v58
    v_mul_f32 v59, v41, v59
    v_cvt_pk_bf16_f32 v32, v48, v49
    v_cvt_pk_bf16_f32 v33, v50, v51
    v_cvt_pk_bf16_f32 v34, v52, v53
    v_cvt_pk_bf16_f32 v35, v54, v55
    v_cvt_pk_bf16_f32 v36, v56, v57
    v_cvt_pk_bf16_f32 v37, v58, v59
    buffer_store_dwordx2 v[32:33], v6, s[24:27], s39 offen sc0 sc1
    buffer_store_dwordx2 v[34:35], v6, s[24:27], s34 offen sc0 sc1
    s_mov_b32 exec_hi, 0
    buffer_store_dwordx2 v[36:37], v46, s[24:27], s35 offen sc0 sc1
    s_branch opq_entry
attB_slow:
    s_mov_b32 s48, 1
    v_mov_b32 v7, 0xf149f2ca
    v_mov_b32 v48, 0
    v_mov_b32 v49, 0
    v_mov_b32 v50, 0
    v_mov_b32 v51, 0
    v_mov_b32 v52, 0
    v_mov_b32 v53, 0
    v_mov_b32 v54, 0
    v_mov_b32 v55, 0
    v_mov_b32 v56, 0
    v_mov_b32 v57, 0
    v_mov_b32 v58, 0
    v_mov_b32 v59, 0
    v_mov_b32 v60, 0
    v_mov_b32 v61, 0
    v_mov_b32 v62, 0
    v_mov_b32 v63, 0
    v_mov_b32 v32, 0
    v_mov_b32 v33, 0
    v_mov_b32 v34, 0
    v_mov_b32 v35, 0
    v_mov_b32 v36, 0
    v_mov_b32 v37, 0
    v_mov_b32 v38, 0
    v_mov_b32 v39, 0
    s_mov_b32 s36, 99
    s_mov_b32 s37, 99
    s_mov_b32 s38, 0
    v_subrev_u32 v5, 163840, v5
attB_slow_loop:
    v_subrev_u32 v3, 2560, v3
    v_subrev_u32 v4, 2560, v4
    ds_read_b128 v[16:19], v3 offset:0
    ds_read_b64 v[14:15], v4 offset:0
    s_waitcnt lgkmcnt(0)
    v_mfma_f32_32x32x16_bf16 v[64:79], v[16:19], v[8:11], 0
    v_mfma_f32_32x32x8_bf16 v[64:79], v[14:15], v[12:13], v[64:79]
    s_nop 11
    v_max3_f32 v7, v7, v64, v65
    v_max3_f32 v7, v7, v66, v67
    v_max3_f32 v7, v7, v68, v69
    v_max3_f32 v7, v7, v70, v71
    v_max3_f32 v7, v7, v72, v73
    v_max3_f32 v7, v7, v74, v75
    v_max3_f32 v7, v7, v76, v77
    v_max3_f32 v7, v7, v78, v79
    s_add_u32 s38, s38, 1
    s_cmp_lt_u32 s38, 64
    s_cbranch_scc1 attB_slow_loop
    s_branch attB_have_m
.p2align 6
opq_entry:
    s_mov_b64 exec, -1
    s_setprio 0
    s_barrier
    s_and_b32 s14, s13, 3
    s_lshr_b32 s15, s13, 2
    v_lshlrev_b32 v2, 4, v0
    s_and_b32 s39, s15, s59
    s_cmp_eq_u32 s39, 0
    s_cbranch_scc1 opq_nowo1
    s_mul_i32 s29, s12, 102400
    s_add_u32 s29, s29, s55
    s_add_u32 s20, s8, s29
    s_addc_u32 s21, s9, 0
    s_mov_b32 s22, 102400
    s_mov_b32 s23, 0x20000
    s_mul_i32 s38, s14, 25600
    s_add_u32 s31, s38, 0
    s_mov_b32 m0, s31
    s_nop 0
    buffer_load_dwordx4 v2, s[20:23], s31 offen offset:0 lds
    buffer_load_dwordx4 v2, s[20:23], s31 offen offset:1024 lds
    buffer_load_dwordx4 v2, s[20:23], s31 offen offset:2048 lds
    buffer_load_dwordx4 v2, s[20:23], s31 offen offset:3072 lds
    s_add_u32 s31, s38, 4096
    s_mov_b32 m0, s31
    s_nop 0
    buffer_load_dwordx4 v2, s[20:23], s31 offen offset:0 lds
    buffer_load_dwordx4 v2, s[20:23], s31 offen offset:1024 lds
    buffer_load_dwordx4 v2, s[20:23], s31 offen offset:2048 lds
    buffer_load_dwordx4 v2, s[20:23], s31 offen offset:3072 lds
    s_waitcnt vmcnt(8)
    s_branch opq_e2
opq_nowo1:
    s_waitcnt vmcnt(0)
opq_e2:
    s_barrier
    s_lshl_b32 s28, s12, 12
    s_lshl_b32 s29, s11, 2
    s_add_u32 s28, s28, s29
    s_cmp_lg_u32 s13, 0
    s_cbranch_scc1 opq_s1_sdone
    s_add_u32 s60, s8, s57
    s_addc_u32 s61, s9, 0
    s_mov_b32 s62, 65536
    s_mov_b32 s63, 0x20000
    v_lshlrev_b32 v1, 7, v0
    v_mov_b32 v167, 1
    s_mov_b32 exec_lo, 0xffffffff
    s_mov_b32 exec_hi, 0
    buffer_store_dword v167, v1, s[60:63], s28 offen sc0 sc1
    s_mov_b64 exec, -1
opq_s1_sdone:
    s_cmp_eq_u32 s39, 0
    s_cbranch_scc1 opq_nowo2
    s_add_u32 s31, s38, 8192
    s_mov_b32 m0, s31
    s_nop 0
    buffer_load_dwordx4 v2, s[20:23], s31 offen offset:0 lds
    buffer_load_dwordx4 v2, s[20:23], s31 offen offset:1024 lds
    buffer_load_dwordx4 v2, s[20:23], s31 offen offset:2048 lds
    buffer_load_dwordx4 v2, s[20:23], s31 offen offset:3072 lds
    s_add_u32 s31, s38, 12288
    s_mov_b32 m0, s31
    s_nop 0
    buffer_load_dwordx4 v2, s[20:23], s31 offen offset:0 lds
    buffer_load_dwordx4 v2, s[20:23], s31 offen offset:1024 lds
    buffer_load_dwordx4 v2, s[20:23], s31 offen offset:2048 lds
    buffer_load_dwordx4 v2, s[20:23], s31 offen offset:3072 lds
    s_add_u32 s31, s38, 16384
    s_mov_b32 m0, s31
    s_nop 0
    buffer_load_dwordx4 v2, s[20:23], s31 offen offset:0 lds
    buffer_load_dwordx4 v2, s[20:23], s31 offen offset:1024 lds
    buffer_load_dwordx4 v2, s[20:23], s31 offen offset:2048 lds
    buffer_load_dwordx4 v2, s[20:23], s31 offen offset:3072 lds
    s_add_u32 s31, s38, 20480
    s_mov_b32 m0, s31
    s_nop 0
    buffer_load_dwordx4 v2, s[20:23], s31 offen offset:0 lds
    buffer_load_dwordx4 v2, s[20:23], s31 offen offset:1024 lds
    buffer_load_dwordx4 v2, s[20:23], s31 offen offset:2048 lds
    buffer_load_dwordx4 v2, s[20:23], s31 offen offset:3072 lds
    s_add_u32 s31, s38, 24576
    s_mov_b32 m0, s31
    s_nop 0
    buffer_load_dwordx4 v2, s[20:23], s31 offen offset:0 lds
opq_nowo2:
    s_mul_i32 s28, s11, 81920
    s_mul_i32 s29, s12, 5120
    s_add_u32 s28, s28, s29
    s_mul_i32 s29, s11, 81920
    s_mul_i32 s30, s12, 160
    s_add_u32 s29, s29, s30
    s_add_u32 s30, s28, s10
    s_mov_b32 s26, 46080
    s_bitcmp1_b32 s54, 0
    s_cselect_b64 s[34:35], -1, 0
    s_cmov_b32 s30, s29
    s_cmov_b32 s26, 80800
    s_add_u32 s24, s4, s30
    s_addc_u32 s25, s5, 0
    s_mov_b32 s27, 0x20000
    s_add_u32 s30, s28, s58
    s_mov_b32 s42, 46080
    s_mov_b32 s46, 0xffff
    s_mov_b32 s47, 0
    s_bitcmp1_b32 s54, 1
    s_cselect_b64 s[36:37], -1, 0
    s_cmov_b32 s30, s29
    s_cmov_b32 s42, 80800
    s_cmov_b32 s46, 0x03030303
    s_cmov_b32 s47, 0x03030303
    s_add_u32 s40, s52, s30
    s_addc_u32 s41, s53, 0
    s_mov_b32 s43, 0x20000
    v_lshrrev_b32 v46, 3, v0
    v_and_b32 v47, 7, v0
    v_cndmask_b32 v44, v47, v46, s[36:37]
    v_cndmask_b32 v45, v46, v47, s[36:37]
    s_lshl_b32 s29, s13, 3
    v_add_u32 v48, s29, v44
    v_mul_u32_u24 v49, 1280, v48
    v_lshl_add_u32 v50, v45, 4, v49
    v_add_u32 v51, 128, v50
    s_mul_i32 s29, s15, 40960
    s_lshl_b32 s28, s14, 7
    s_add_u32 s29, s29, s28
    v_lshlrev_b32 v52, 9, v45
    v_lshl_add_u32 v52, v44, 4, v52
    v_add_u32 v52, s29, v52
    v_add_u32 v53, 4096, v52
    v_cndmask_b32 v11, v52, v50, s[34:35]
    v_cndmask_b32 v12, v53, v51, s[34:35]
    v_cndmask_b32 v13, v52, v50, s[36:37]
    v_cndmask_b32 v14, v53, v51, s[36:37]
    buffer_load_dwordx4 v[16:19], v11, s[24:27], 0 offen
    s_mov_b64 exec, s[46:47]
    buffer_load_dwordx4 v[20:23], v12, s[24:27], 0 offen
    s_mov_b64 exec, -1
    v_mul_u32_u24 v49, 336, v48
    v_add_u32 v49, 102400, v49
    v_lshl_add_u32 v9, v45, 5, v49
    v_add_u32 v10, 256, v9
    s_lshl_b32 s29, s11, 3
    s_add_u32 s29, s29, s12
    s_lshl_b32 s29, s29, 9
    v_lshl_add_u32 v15, v48, 3, s29
    s_add_u32 s28, s58, 13107200
    s_add_u32 s48, s8, s28
    s_addc_u32 s49, s9, 0
    s_mov_b32 s50, 0x20000
    s_mov_b32 s51, 0x20000
    v_lshrrev_b32 v44, 4, v0
    v_and_b32 v45, 15, v0
    s_lshl_b32 s28, s14, 4
    v_add_u32 v45, s28, v45
    v_mul_u32_u24 v8, 336, v45
    v_lshl_add_u32 v8, v44, 4, v8
    s_mul_i32 s28, s15, 21504
    s_add_u32 s28, s28, 102400
    v_add_u32 v8, s28, v8
    s_lshl_b32 s28, s11, 6
    v_add_u32 v45, s28, v45
    v_lshlrev_b32 v4, 15, v44
    v_lshl_add_u32 v4, v45, 4, v4
    v_lshlrev_b32 v5, 14, v44
    v_lshl_add_u32 v5, v45, 3, v5
    s_lshl_b32 s28, s15, 17
    v_add_u32 v4, s28, v4
    v_add_u32 v5, s28, v5
    v_lshrrev_b32 v44, 2, v0
    v_and_b32 v45, 3, v0
    v_mul_u32_u24 v44, 160, v44
    v_lshl_add_u32 v44, v45, 3, v44
    s_mul_i32 s28, s15, 5120
    v_add_u32 v6, s28, v44
    v_add_u32 v7, 61440, v6
    s_add_u32 s28, s10, 2621440
    s_add_u32 s16, s8, s28
    s_addc_u32 s17, s9, 0
    s_mov_b32 s18, 2621440
    s_mov_b32 s19, 0x20000
    s_mov_b32 s38, 0x3f803f80
    s_and_b32 s29, s2, 7
    s_lshl_b32 s29, s29, 12
    s_lshr_b32 s30, s2, 3
    s_lshl_b32 s30, s30, 7
    s_add_u32 s29, s29, s30
    v_mov_b32 v24, 0
    v_mov_b32 v25, 0
    v_mov_b32 v26, 0
    v_mov_b32 v27, 0
    v_mov_b32 v28, 0
    v_mov_b32 v29, 0
    v_mov_b32 v30, 0
    v_mov_b32 v31, 0
    v_mov_b32 v32, 0
    v_mov_b32 v33, 0
    v_mov_b32 v34, 0
    v_mov_b32 v35, 0
    v_mov_b32 v36, 0
    v_mov_b32 v37, 0
    v_mov_b32 v38, 0
    v_mov_b32 v39, 0
    v_mov_b32 v40, 0
    v_mov_b32 v41, 0
    v_mov_b32 v42, 0
    v_mov_b32 v43, 0
    s_waitcnt vmcnt(0)
    s_cmp_lg_u32 s13, 0
    s_cbranch_scc1 opq_s1_done
    s_add_u32 s60, s8, s57
    s_addc_u32 s61, s9, 0
    s_mov_b32 s62, 65536
    s_mov_b32 s63, 0x20000
    v_lshlrev_b32 v1, 2, v0
    s_mov_b32 exec_lo, 0xffffffff
    s_mov_b32 exec_hi, 0
    s_mov_b32 s3, 0
opq_s1_poll:
    buffer_load_dword v164, v1, s[60:63], s29 offen sc0 sc1
    s_add_u32 s3, s3, 1
    s_waitcnt vmcnt(0)
    v_cmp_eq_u32 vcc, 0, v164
    s_cbranch_vccz opq_s1_out
    s_cmp_lt_u32 s3, 0x400000
    s_cbranch_scc1 opq_s1_poll
opq_s1_out:
    s_mov_b64 exec, -1
opq_s1_done:
    s_barrier
    s_mov_b32 s28, 0
    buffer_load_dwordx4 v[44:47], v4, s[16:19], s28 offen sc1
    ds_read_b64_tr_b16 v[84:85], v6 offset:0
    ds_read_b64_tr_b16 v[86:87], v6 offset:2560
    ds_read_b64_tr_b16 v[88:89], v6 offset:32
    s_mov_b32 s28, 262144
    buffer_load_dwordx4 v[48:51], v4, s[16:19], s28 offen sc1
    ds_read_b64_tr_b16 v[90:91], v6 offset:2592
    ds_read_b64_tr_b16 v[92:93], v6 offset:64
    ds_read_b64_tr_b16 v[94:95], v6 offset:2624
    s_mov_b32 s28, 524288
    buffer_load_dwordx4 v[52:55], v4, s[16:19], s28 offen sc1
    ds_read_b64_tr_b16 v[96:97], v6 offset:96
    ds_read_b64_tr_b16 v[98:99], v6 offset:2656
    ds_read_b64_tr_b16 v[100:101], v6 offset:128
    s_mov_b32 s28, 786432
    buffer_load_dwordx4 v[56:59], v4, s[16:19], s28 offen sc1
    ds_read_b64_tr_b16 v[102:103], v6 offset:2688
    ds_read_b64_tr_b16 v[104:105], v6 offset:10240
    ds_read_b64_tr_b16 v[106:107], v6 offset:12800
    s_mov_b32 s28, 1048576
    buffer_load_dwordx4 v[60:63], v4, s[16:19], s28 offen sc1
    ds_read_b64_tr_b16 v[108:109], v6 offset:10272
    ds_read_b64_tr_b16 v[110:111], v6 offset:12832
    s_waitcnt lgkmcnt(10)
    ds_read_b64_tr_b16 v[112:113], v6 offset:10304
    s_mov_b32 s28, 1310720
    buffer_load_dwordx4 v[64:67], v4, s[16:19], s28 offen sc1
    ds_read_b64_tr_b16 v[114:115], v6 offset:12864
    ds_read_b64_tr_b16 v[116:117], v6 offset:10336
    ds_read_b64_tr_b16 v[118:119], v6 offset:12896
    s_mov_b32 s28, 1572864
    buffer_load_dwordx4 v[68:71], v4, s[16:19], s28 offen sc1
    s_waitcnt lgkmcnt(10)
    ds_read_b64_tr_b16 v[120:121], v6 offset:10368
    ds_read_b64_tr_b16 v[122:123], v6 offset:12928
    ds_read_b64_tr_b16 v[124:125], v6 offset:20480
    s_mov_b32 s28, 1835008
    buffer_load_dwordx4 v[72:75], v4, s[16:19], s28 offen sc1
    ds_read_b64_tr_b16 v[126:127], v6 offset:23040
    s_waitcnt lgkmcnt(10)
    ds_read_b64_tr_b16 v[128:129], v6 offset:20512
    ds_read_b64_tr_b16 v[130:131], v6 offset:23072
    s_mov_b32 s28, 2097152
    buffer_load_dwordx2 v[76:77], v5, s[16:19], s28 offen sc1
    ds_read_b64_tr_b16 v[132:133], v6 offset:20544
    ds_read_b64_tr_b16 v[134:135], v6 offset:23104
    s_waitcnt lgkmcnt(10)
    ds_read_b64_tr_b16 v[136:137], v6 offset:20576
    s_mov_b32 s28, 2162688
    buffer_load_dwordx2 v[78:79], v5, s[16:19], s28 offen sc1
    ds_read_b64_tr_b16 v[138:139], v6 offset:23136
    ds_read_b64_tr_b16 v[140:141], v6 offset:20608
    ds_read_b64_tr_b16 v[142:143], v6 offset:23168
    s_mov_b32 s28, 2359296
    buffer_load_dwordx2 v[80:81], v5, s[16:19], s28 offen sc1
    s_waitcnt lgkmcnt(10)
    ds_read_b64_tr_b16 v[144:145], v6 offset:30720
    ds_read_b64_tr_b16 v[146:147], v6 offset:33280
    ds_read_b64_tr_b16 v[148:149], v6 offset:30752
    s_mov_b32 s28, 2424832
    buffer_load_dwordx2 v[82:83], v5, s[16:19], s28 offen sc1
    ds_read_b64_tr_b16 v[150:151], v6 offset:33312
    s_waitcnt lgkmcnt(10)
    ds_read_b64_tr_b16 v[152:153], v6 offset:30784
    ds_read_b64_tr_b16 v[154:155], v6 offset:33344
    ds_read_b64_tr_b16 v[156:157], v6 offset:30816
    ds_read_b64_tr_b16 v[158:159], v6 offset:33376
    s_waitcnt lgkmcnt(10)
    ds_read_b64_tr_b16 v[160:161], v6 offset:30848
    ds_read_b64_tr_b16 v[162:163], v6 offset:33408
    s_waitcnt vmcnt(11) lgkmcnt(13)
    v_mfma_f32_16x16x32_bf16 v[24:27], v[84:87], v[44:47], v[24:27]
    ds_read_b64_tr_b16 v[84:85], v6 offset:40960
    ds_read_b64_tr_b16 v[86:87], v6 offset:43520
    s_waitcnt lgkmcnt(13)
    v_mfma_f32_16x16x32_bf16 v[28:31], v[88:91], v[44:47], v[28:31]
    ds_read_b64_tr_b16 v[88:89], v6 offset:40992
    ds_read_b64_tr_b16 v[90:91], v6 offset:43552
    s_waitcnt lgkmcnt(13)
    v_mfma_f32_16x16x32_bf16 v[32:35], v[92:95], v[44:47], v[32:35]
    ds_read_b64_tr_b16 v[92:93], v6 offset:41024
    ds_read_b64_tr_b16 v[94:95], v6 offset:43584
    s_waitcnt lgkmcnt(13)
    v_mfma_f32_16x16x32_bf16 v[36:39], v[96:99], v[44:47], v[36:39]
    ds_read_b64_tr_b16 v[96:97], v6 offset:41056
    ds_read_b64_tr_b16 v[98:99], v6 offset:43616
    s_waitcnt lgkmcnt(13)
    v_mfma_f32_16x16x32_bf16 v[40:43], v[100:103], v[44:47], v[40:43]
    ds_read_b64_tr_b16 v[100:101], v6 offset:41088
    ds_read_b64_tr_b16 v[102:103], v6 offset:43648
    s_waitcnt vmcnt(10) lgkmcnt(13)
    v_mfma_f32_16x16x32_bf16 v[24:27], v[104:107], v[48:51], v[24:27]
    ds_read_b64_tr_b16 v[104:105], v6 offset:51200
    ds_read_b64_tr_b16 v[106:107], v6 offset:53760
    s_waitcnt lgkmcnt(13)
    v_mfma_f32_16x16x32_bf16 v[28:31], v[108:111], v[48:51], v[28:31]
    ds_read_b64_tr_b16 v[108:109], v6 offset:51232
    ds_read_b64_tr_b16 v[110:111], v6 offset:53792
    s_waitcnt lgkmcnt(13)
    v_mfma_f32_16x16x32_bf16 v[32:35], v[112:115], v[48:51], v[32:35]
    ds_read_b64_tr_b16 v[112:113], v6 offset:51264
    ds_read_b64_tr_b16 v[114:115], v6 offset:53824
    s_waitcnt lgkmcnt(13)
    v_mfma_f32_16x16x32_bf16 v[36:39], v[116:119], v[48:51], v[36:39]
    ds_read_b64_tr_b16 v[116:117], v6 offset:51296
    ds_read_b64_tr_b16 v[118:119], v6 offset:53856
    s_waitcnt lgkmcnt(13)
    v_mfma_f32_16x16x32_bf16 v[40:43], v[120:123], v[48:51], v[40:43]
    ds_read_b64_tr_b16 v[120:121], v6 offset:51328
    ds_read_b64_tr_b16 v[122:123], v6 offset:53888
    s_waitcnt vmcnt(9) lgkmcnt(13)
    v_mfma_f32_16x16x32_bf16 v[24:27], v[124:127], v[52:55], v[24:27]
    ds_read_b64_tr_b16 v[124:125], v7 offset:0
    ds_read_b64_tr_b16 v[126:127], v7 offset:2560
    s_waitcnt lgkmcnt(13)
    v_mfma_f32_16x16x32_bf16 v[28:31], v[128:131], v[52:55], v[28:31]
    ds_read_b64_tr_b16 v[128:129], v7 offset:32
    ds_read_b64_tr_b16 v[130:131], v7 offset:2592
    s_waitcnt lgkmcnt(13)
    v_mfma_f32_16x16x32_bf16 v[32:35], v[132:135], v[52:55], v[32:35]
    ds_read_b64_tr_b16 v[132:133], v7 offset:64
    ds_read_b64_tr_b16 v[134:135], v7 offset:2624
    s_waitcnt lgkmcnt(13)
    v_mfma_f32_16x16x32_bf16 v[36:39], v[136:139], v[52:55], v[36:39]
    ds_read_b64_tr_b16 v[136:137], v7 offset:96
    ds_read_b64_tr_b16 v[138:139], v7 offset:2656
    s_waitcnt lgkmcnt(13)
    v_mfma_f32_16x16x32_bf16 v[40:43], v[140:143], v[52:55], v[40:43]
    ds_read_b64_tr_b16 v[140:141], v7 offset:128
    ds_read_b64_tr_b16 v[142:143], v7 offset:2688
    s_waitcnt vmcnt(8) lgkmcnt(13)
    v_mfma_f32_16x16x32_bf16 v[24:27], v[144:147], v[56:59], v[24:27]
    ds_read_b64_tr_b16 v[144:145], v7 offset:10240
    ds_read_b64_tr_b16 v[146:147], v7 offset:12800
    s_waitcnt lgkmcnt(13)
    v_mfma_f32_16x16x32_bf16 v[28:31], v[148:151], v[56:59], v[28:31]
    ds_read_b64_tr_b16 v[148:149], v7 offset:10272
    ds_read_b64_tr_b16 v[150:151], v7 offset:12832
    s_waitcnt lgkmcnt(13)
    v_mfma_f32_16x16x32_bf16 v[32:35], v[152:155], v[56:59], v[32:35]
    ds_read_b64_tr_b16 v[152:153], v7 offset:10304
    ds_read_b64_tr_b16 v[154:155], v7 offset:12864
    s_waitcnt lgkmcnt(13)
    v_mfma_f32_16x16x32_bf16 v[36:39], v[156:159], v[56:59], v[36:39]
    ds_read_b64_tr_b16 v[156:157], v7 offset:10336
    ds_read_b64_tr_b16 v[158:159], v7 offset:12896
    s_waitcnt lgkmcnt(13)
    v_mfma_f32_16x16x32_bf16 v[40:43], v[160:163], v[56:59], v[40:43]
    ds_read_b64_tr_b16 v[160:161], v7 offset:10368
    ds_read_b64_tr_b16 v[162:163], v7 offset:12928
    s_waitcnt vmcnt(7) lgkmcnt(13)
    v_mfma_f32_16x16x32_bf16 v[24:27], v[84:87], v[60:63], v[24:27]
    ds_read_b64_tr_b16 v[84:85], v7 offset:20480
    ds_read_b64_tr_b16 v[86:87], v7 offset:23040
    s_waitcnt lgkmcnt(13)
    v_mfma_f32_16x16x32_bf16 v[28:31], v[88:91], v[60:63], v[28:31]
    ds_read_b64_tr_b16 v[88:89], v7 offset:20512
    ds_read_b64_tr_b16 v[90:91], v7 offset:23072
    s_waitcnt lgkmcnt(13)
    v_mfma_f32_16x16x32_bf16 v[32:35], v[92:95], v[60:63], v[32:35]
    ds_read_b64_tr_b16 v[92:93], v7 offset:20544
    ds_read_b64_tr_b16 v[94:95], v7 offset:23104
    s_waitcnt lgkmcnt(13)
    v_mfma_f32_16x16x32_bf16 v[36:39], v[96:99], v[60:63], v[36:39]
    ds_read_b64_tr_b16 v[96:97], v7 offset:20576
    ds_read_b64_tr_b16 v[98:99], v7 offset:23136
    s_waitcnt lgkmcnt(13)
    v_mfma_f32_16x16x32_bf16 v[40:43], v[100:103], v[60:63], v[40:43]
    ds_read_b64_tr_b16 v[100:101], v7 offset:20608
    ds_read_b64_tr_b16 v[102:103], v7 offset:23168
    s_waitcnt vmcnt(6) lgkmcnt(13)
    v_mfma_f32_16x16x32_bf16 v[24:27], v[104:107], v[64:67], v[24:27]
    ds_read_b64_tr_b16 v[104:105], v7 offset:30720
    ds_read_b64_tr_b16 v[106:107], v7 offset:33280
    s_waitcnt lgkmcnt(13)
    v_mfma_f32_16x16x32_bf16 v[28:31], v[108:111], v[64:67], v[28:31]
    ds_read_b64_tr_b16 v[108:109], v7 offset:30752
    ds_read_b64_tr_b16 v[110:111], v7 offset:33312
    s_waitcnt lgkmcnt(13)
    v_mfma_f32_16x16x32_bf16 v[32:35], v[112:115], v[64:67], v[32:35]
    ds_read_b64_tr_b16 v[112:113], v7 offset:30784
    ds_read_b64_tr_b16 v[114:115], v7 offset:33344
    s_waitcnt lgkmcnt(13)
    v_mfma_f32_16x16x32_bf16 v[36:39], v[116:119], v[64:67], v[36:39]
    ds_read_b64_tr_b16 v[116:117], v7 offset:30816
    ds_read_b64_tr_b16 v[118:119], v7 offset:33376
    s_waitcnt lgkmcnt(13)
    v_mfma_f32_16x16x32_bf16 v[40:43], v[120:123], v[64:67], v[40:43]
    ds_read_b64_tr_b16 v[120:121], v7 offset:30848
    ds_read_b64_tr_b16 v[122:123], v7 offset:33408
    s_waitcnt vmcnt(5) lgkmcnt(13)
    v_mfma_f32_16x16x32_bf16 v[24:27], v[124:127], v[68:71], v[24:27]
    s_waitcnt lgkmcnt(13)
    v_mfma_f32_16x16x32_bf16 v[28:31], v[128:131], v[68:71], v[28:31]
    s_waitcnt lgkmcnt(13)
    v_mfma_f32_16x16x32_bf16 v[32:35], v[132:135], v[68:71], v[32:35]
    s_waitcnt lgkmcnt(13)
    v_mfma_f32_16x16x32_bf16 v[36:39], v[136:139], v[68:71], v[36:39]
    s_waitcnt lgkmcnt(13)
    v_mfma_f32_16x16x32_bf16 v[40:43], v[140:143], v[68:71], v[40:43]
    s_waitcnt vmcnt(4) lgkmcnt(13)
    v_mfma_f32_16x16x32_bf16 v[24:27], v[144:147], v[72:75], v[24:27]
    s_waitcnt lgkmcnt(13)
    v_mfma_f32_16x16x32_bf16 v[28:31], v[148:151], v[72:75], v[28:31]
    s_waitcnt lgkmcnt(13)
    v_mfma_f32_16x16x32_bf16 v[32:35], v[152:155], v[72:75], v[32:35]
    s_waitcnt lgkmcnt(13)
    v_mfma_f32_16x16x32_bf16 v[36:39], v[156:159], v[72:75], v[36:39]
    s_waitcnt lgkmcnt(13)
    v_mfma_f32_16x16x32_bf16 v[40:43], v[160:163], v[72:75], v[40:43]
    s_waitcnt vmcnt(2) lgkmcnt(13)
    v_mfma_f32_16x16x32_bf16 v[24:27], v[84:87], v[76:79], v[24:27]
    s_waitcnt lgkmcnt(13)
    v_mfma_f32_16x16x32_bf16 v[28:31], v[88:91], v[76:79], v[28:31]
    s_waitcnt lgkmcnt(13)
    v_mfma_f32_16x16x32_bf16 v[32:35], v[92:95], v[76:79], v[32:35]
    s_waitcnt lgkmcnt(12)
    v_mfma_f32_16x16x32_bf16 v[36:39], v[96:99], v[76:79], v[36:39]
    s_waitcnt lgkmcnt(10)
    v_mfma_f32_16x16x32_bf16 v[40:43], v[100:103], v[76:79], v[40:43]
    s_waitcnt vmcnt(0) lgkmcnt(8)
    v_mfma_f32_16x16x32_bf16 v[24:27], v[104:107], v[80:83], v[24:27]
    s_waitcnt lgkmcnt(6)
    v_mfma_f32_16x16x32_bf16 v[28:31], v[108:111], v[80:83], v[28:31]
    s_waitcnt lgkmcnt(4)
    v_mfma_f32_16x16x32_bf16 v[32:35], v[112:115], v[80:83], v[32:35]
    s_waitcnt lgkmcnt(2)
    v_mfma_f32_16x16x32_bf16 v[36:39], v[116:119], v[80:83], v[36:39]
    s_waitcnt lgkmcnt(0)
    v_mfma_f32_16x16x32_bf16 v[40:43], v[120:123], v[80:83], v[40:43]
    ds_write_b128 v8, v[24:27] offset:0
    s_nop 0
    ds_write_b128 v8, v[28:31] offset:64
    s_nop 0
    ds_write_b128 v8, v[32:35] offset:128
    s_nop 0
    ds_write_b128 v8, v[36:39] offset:192
    s_nop 0
    ds_write_b128 v8, v[40:43] offset:256
    v_lshlrev_b32 v100, 16, v16
    v_and_b32 v101, 0xffff0000, v16
    v_lshlrev_b32 v102, 16, v17
    v_and_b32 v103, 0xffff0000, v17
    v_lshlrev_b32 v104, 16, v18
    v_and_b32 v105, 0xffff0000, v18
    v_lshlrev_b32 v106, 16, v19
    v_and_b32 v107, 0xffff0000, v19
    v_lshlrev_b32 v108, 16, v20
    v_and_b32 v109, 0xffff0000, v20
    v_lshlrev_b32 v110, 16, v21
    v_and_b32 v111, 0xffff0000, v21
    v_lshlrev_b32 v112, 16, v22
    v_and_b32 v113, 0xffff0000, v22
    v_lshlrev_b32 v114, 16, v23
    v_and_b32 v115, 0xffff0000, v23
    v_mov_b32 v92, 0
    v_mov_b32 v93, 0
    s_waitcnt lgkmcnt(0)
    s_barrier
    ds_read_b128 v[44:47], v9 offset:0
    ds_read_b128 v[48:51], v9 offset:16
    ds_read_b128 v[52:55], v9 offset:21504
    ds_read_b128 v[56:59], v9 offset:21520
    ds_read_b128 v[60:63], v10 offset:0
    ds_read_b128 v[64:67], v10 offset:16
    ds_read_b128 v[68:71], v10 offset:21504
    ds_read_b128 v[72:75], v10 offset:21520
    s_waitcnt lgkmcnt(6)
    v_add_f32 v100, v100, v44
    v_add_f32 v101, v101, v45
    v_add_f32 v102, v102, v46
    v_add_f32 v103, v103, v47
    v_add_f32 v104, v104, v48
    v_add_f32 v105, v105, v49
    v_add_f32 v106, v106, v50
    v_add_f32 v107, v107, v51
    s_waitcnt lgkmcnt(4)
    v_add_f32 v100, v100, v52
    v_add_f32 v101, v101, v53
    v_add_f32 v102, v102, v54
    v_add_f32 v103, v103, v55
    v_add_f32 v104, v104, v56
    v_add_f32 v105, v105, v57
    v_add_f32 v106, v106, v58
    v_add_f32 v107, v107, v59
    v_cvt_pk_bf16_f32 v84, v100, v101
    v_cvt_pk_bf16_f32 v85, v102, v103
    v_cvt_pk_bf16_f32 v86, v104, v105
    v_cvt_pk_bf16_f32 v87, v106, v107
    s_waitcnt lgkmcnt(2)
    v_add_f32 v108, v108, v60
    v_add_f32 v109, v109, v61
    v_add_f32 v110, v110, v62
    v_add_f32 v111, v111, v63
    v_add_f32 v112, v112, v64
    v_add_f32 v113, v113, v65
    v_add_f32 v114, v114, v66
    v_add_f32 v115, v115, v67
    s_waitcnt lgkmcnt(0)
    v_add_f32 v108, v108, v68
    v_add_f32 v109, v109, v69
    v_add_f32 v110, v110, v70
    v_add_f32 v111, v111, v71
    v_add_f32 v112, v112, v72
    v_add_f32 v113, v113, v73
    v_add_f32 v114, v114, v74
    v_add_f32 v115, v115, v75
    v_cvt_pk_bf16_f32 v88, v108, v109
    v_cvt_pk_bf16_f32 v89, v110, v111
    v_cvt_pk_bf16_f32 v90, v112, v113
    v_cvt_pk_bf16_f32 v91, v114, v115
    s_bitcmp1_b32 s54, 1
    s_cbranch_scc0 opq_wt
    buffer_store_dwordx4 v[84:87], v13, s[40:43], 0 offen
    s_mov_b64 exec, s[46:47]
    buffer_store_dwordx4 v[88:91], v14, s[40:43], 0 offen
    s_branch opq_fin
opq_wt:
    buffer_store_dwordx4 v[84:87], v13, s[40:43], 0 offen sc0 sc1
    s_mov_b64 exec, s[46:47]
    buffer_store_dwordx4 v[88:91], v14, s[40:43], 0 offen sc0 sc1
    v_dot2_f32_bf16 v92, v88, s38, v92
    v_dot2_f32_bf16 v93, v88, v88, v93
    v_dot2_f32_bf16 v92, v89, s38, v92
    v_dot2_f32_bf16 v93, v89, v89, v93
    v_dot2_f32_bf16 v92, v90, s38, v92
    v_dot2_f32_bf16 v93, v90, v90, v93
    v_dot2_f32_bf16 v92, v91, s38, v92
    v_dot2_f32_bf16 v93, v91, v91, v93
    s_mov_b64 exec, -1
    v_dot2_f32_bf16 v92, v84, s38, v92
    v_dot2_f32_bf16 v93, v84, v84, v93
    v_dot2_f32_bf16 v92, v85, s38, v92
    v_dot2_f32_bf16 v93, v85, v85, v93
    v_dot2_f32_bf16 v92, v86, s38, v92
    v_dot2_f32_bf16 v93, v86, v86, v93
    v_dot2_f32_bf16 v92, v87, s38, v92
    v_dot2_f32_bf16 v93, v87, v87, v93
    s_nop 1
    v_add_f32_dpp v92, v92, v92 row_ror:8 row_mask:0xf bank_mask:0xf
    v_add_f32_dpp v93, v93, v93 row_ror:8 row_mask:0xf bank_mask:0xf
    v_mov_b32 v94, v92
    v_mov_b32 v95, v93
    s_nop 0
    v_permlane16_swap_b32 v94, v92
    v_permlane16_swap_b32 v95, v93
    v_add_f32 v92, v92, v94
    v_add_f32 v93, v93, v95
    v_mov_b32 v94, v92
    v_mov_b32 v95, v93
    s_nop 0
    v_permlane32_swap_b32 v94, v92
    v_permlane32_swap_b32 v95, v93
    v_add_f32 v92, v92, v94
    v_add_f32 v93, v93, v95
    s_mov_b64 exec, 0xff
    buffer_store_dwordx2 v[92:93], v15, s[48:51], 0 offen sc0 sc1
    s_mov_b64 exec, -1
    s_lshr_b32 s30, s11, 1
    s_lshl_b32 s30, s30, 11
    s_and_b32 s31, s11, 1
    s_lshl_b32 s31, s31, 3
    s_add_u32 s31, s31, s12
    s_lshl_b32 s31, s31, 2
    s_add_u32 s30, s30, s31
    s_add_u32 s30, s30, 32768
    s_and_b32 s28, s2, 7
    s_lshr_b32 s29, s2, 3
    s_lshr_b32 s11, s28, 1
    s_lshl_b32 s11, s11, 2
    s_and_b32 s12, s29, 3
    s_add_u32 s11, s11, s12
    s_and_b32 s12, s28, 1
    s_lshl_b32 s12, s12, 3
    s_lshr_b32 s29, s29, 2
    s_add_u32 s12, s12, s29
    s_lshl_b32 s31, s11, 4
    s_add_u32 s31, s31, s12
    s_lshl_b32 s31, s31, 7
    s_add_u32 s31, s31, 32768
    s_mov_b32 s38, 1.0
    s_cmp_lt_u32 s12, 5
    s_cmov_b32 s38, 0x3ea52b5c
    s_cmp_ge_u32 s12, 15
    s_cbranch_scc1 opq_idle
    s_cmp_eq_u32 s15, 0
    s_cbranch_scc1 opq_qcons
    s_lshl_b32 s29, s12, 8
    s_add_u32 s20, s6, s29
    s_addc_u32 s21, s7, 0
    s_sub_u32 s22, 2457600, s29
    s_mov_b32 s23, 0x20000
    v_lshrrev_b32 v3, 4, v0
    v_lshrrev_b32 v4, 2, v0
    v_xor_b32 v4, v4, v3
    v_and_b32 v4, 3, v4
    v_and_b32 v5, 3, v0
    s_lshl_b32 s29, s14, 2
    v_add_u32 v3, s29, v3
    v_mul_u32_u24 v3, 3840, v3
    v_lshl_add_u32 v3, v4, 6, v3
    v_lshl_add_u32 v3, v5, 4, v3
    s_lshl_b32 s35, s14, 10
    s_waitcnt vmcnt(0)
    s_barrier
    s_add_u32 m0, s35, 45056
    s_mov_b32 s34, 675840
    buffer_load_dwordx4 v3, s[20:23], s34 offen lds
    s_add_u32 m0, s35, 49152
    s_mov_b32 s34, 737280
    buffer_load_dwordx4 v3, s[20:23], s34 offen lds
    s_add_u32 m0, s35, 53248
    s_mov_b32 s34, 798720
    buffer_load_dwordx4 v3, s[20:23], s34 offen lds
    s_add_u32 m0, s35, 57344
    s_mov_b32 s34, 860160
    buffer_load_dwordx4 v3, s[20:23], s34 offen lds
    s_add_u32 m0, s35, 61440
    s_mov_b32 s34, 921600
    buffer_load_dwordx4 v3, s[20:23], s34 offen lds
    s_add_u32 m0, s35, 65536
    s_mov_b32 s34, 983040
    buffer_load_dwordx4 v3, s[20:23], s34 offen lds
    s_add_u32 m0, s35, 69632
    s_mov_b32 s34, 1044480
    buffer_load_dwordx4 v3, s[20:23], s34 offen lds
    s_add_u32 m0, s35, 73728
    s_mov_b32 s34, 1105920
    buffer_load_dwordx4 v3, s[20:23], s34 offen lds
    s_add_u32 m0, s35, 77824
    s_mov_b32 s34, 1167360
    buffer_load_dwordx4 v3, s[20:23], s34 offen lds
    s_add_u32 m0, s35, 81920
    s_mov_b32 s34, 1228800
    buffer_load_dwordx4 v3, s[20:23], s34 offen lds
    s_add_u32 m0, s35, 86016
    s_mov_b32 s34, 1290240
    buffer_load_dwordx4 v3, s[20:23], s34 offen lds
    s_add_u32 m0, s35, 90112
    s_mov_b32 s34, 1351680
    buffer_load_dwordx4 v3, s[20:23], s34 offen lds
    s_add_u32 m0, s35, 94208
    s_mov_b32 s34, 1413120
    buffer_load_dwordx4 v3, s[20:23], s34 offen lds
    s_add_u32 m0, s35, 98304
    s_mov_b32 s34, 1474560
    buffer_load_dwordx4 v3, s[20:23], s34 offen lds
    s_add_u32 m0, s35, 102400
    s_mov_b32 s34, 1536000
    buffer_load_dwordx4 v3, s[20:23], s34 offen lds
    s_add_u32 m0, s35, 106496
    s_mov_b32 s34, 1597440
    buffer_load_dwordx4 v3, s[20:23], s34 offen lds
    s_add_u32 m0, s35, 110592
    s_mov_b32 s34, 1658880
    buffer_load_dwordx4 v3, s[20:23], s34 offen lds
    s_add_u32 m0, s35, 114688
    s_mov_b32 s34, 1720320
    buffer_load_dwordx4 v3, s[20:23], s34 offen lds
    s_add_u32 m0, s35, 118784
    s_mov_b32 s34, 1781760
    buffer_load_dwordx4 v3, s[20:23], s34 offen lds
    s_add_u32 m0, s35, 122880
    s_mov_b32 s34, 1843200
    buffer_load_dwordx4 v3, s[20:23], s34 offen lds
    s_add_u32 m0, s35, 126976
    s_mov_b32 s34, 1904640
    buffer_load_dwordx4 v3, s[20:23], s34 offen lds
    s_add_u32 m0, s35, 131072
    s_mov_b32 s34, 1966080
    buffer_load_dwordx4 v3, s[20:23], s34 offen lds
    s_add_u32 m0, s35, 135168
    s_mov_b32 s34, 2027520
    buffer_load_dwordx4 v3, s[20:23], s34 offen lds
    s_add_u32 m0, s35, 139264
    s_mov_b32 s34, 2088960
    buffer_load_dwordx4 v3, s[20:23], s34 offen lds
    s_add_u32 m0, s35, 143360
    s_mov_b32 s34, 2150400
    buffer_load_dwordx4 v3, s[20:23], s34 offen lds
    s_add_u32 m0, s35, 147456
    s_mov_b32 s34, 2211840
    buffer_load_dwordx4 v3, s[20:23], s34 offen lds
    s_add_u32 m0, s35, 151552
    s_mov_b32 s34, 2273280
    buffer_load_dwordx4 v3, s[20:23], s34 offen lds
    s_add_u32 m0, s35, 155648
    s_mov_b32 s34, 2334720
    buffer_load_dwordx4 v3, s[20:23], s34 offen lds
    s_add_u32 m0, s35, 159744
    s_mov_b32 s34, 2396160
    buffer_load_dwordx4 v3, s[20:23], s34 offen lds
    v_lshrrev_b32 v4, 5, v0
    v_and_b32 v5, 31, v0
    v_lshlrev_b32 v6, 3, v5
    v_lshl_add_u32 v6, v4, 11, v6
    s_lshl_b32 s28, s11, 13
    s_lshr_b32 s29, s14, 1
    s_lshl_b32 s29, s29, 12
    s_add_u32 s28, s28, s29
    s_and_b32 s29, s14, 1
    s_lshl_b32 s29, s29, 8
    s_add_u32 s28, s28, s29
    s_lshl_b32 s29, s14, 7
    v_lshl_add_u32 v7, v5, 2, s29
    s_mov_b32 s20, s8
    s_mov_b32 s21, s9
    s_mov_b32 s22, 0x1000000
    s_lshl_b32 s36, s12, 10
    s_add_u32 s36, s36, s56
    s_barrier
    buffer_load_dwordx2 v[8:9], v6, s[48:51], s28 offen offset:0 sc1
    buffer_load_dwordx2 v[10:11], v6, s[48:51], s28 offen offset:512 sc1
    buffer_load_dwordx2 v[12:13], v6, s[48:51], s28 offen offset:1024 sc1
    buffer_load_dwordx2 v[14:15], v6, s[48:51], s28 offen offset:1536 sc1
    s_waitcnt vmcnt(0)
    v_add_f32 v8, v8, v10
    v_add_f32 v9, v9, v11
    v_add_f32 v12, v12, v14
    v_add_f32 v13, v13, v15
    v_add_f32 v8, v8, v12
    v_add_f32 v9, v9, v13
    v_mov_b32 v10, v8
    v_mov_b32 v11, v9
    s_nop 0
    v_permlane32_swap_b32 v10, v8
    v_permlane32_swap_b32 v11, v9
    v_add_f32 v8, v8, v10
    v_add_f32 v9, v9, v11
    v_mul_f32 v8, 0x3acccccd, v8
    v_mul_f32 v9, 0x3acccccd, v9
    v_fma_f32 v9, -v8, v8, v9
    v_max_f32 v9, 0, v9
    v_cvt_pk_bf16_f32 v10, v8, v9
    v_and_b32 v9, 0xffff0000, v10
    v_lshlrev_b32 v8, 16, v10
    v_add_f32 v9, 0x3727c5ac, v9
    v_cvt_pk_bf16_f32 v9, v9, v9
    v_and_b32 v9, 0xffff0000, v9
    v_sqrt_f32 v9, v9
    s_nop 0
    v_cvt_pk_bf16_f32 v9, v9, v9
    v_and_b32 v9, 0xffff0000, v9
    v_rcp_f32 v9, v9
    v_xor_b32 v13, 0x80000000, v8
    v_mul_f32 v12, s38, v9
    s_barrier
    s_mov_b32 m0, 1024
    ds_write_b32 v7, v12
    ds_write_b32 v7, v13 offset:512
    buffer_load_dwordx4 v2, s[20:23], s36 offen lds
    s_waitcnt vmcnt(0) lgkmcnt(0)
    s_barrier
    s_endpgm
opq_w8:
    s_bitcmp1_b32 s54, 1
    s_cbranch_scc1 opq_w8end
    s_and_b32 s28, s2, 1
    s_lshl_b32 s28, s28, 3
    s_lshr_b32 s29, s2, 5
    s_add_u32 s12, s28, s29
    s_cmp_ge_u32 s12, 15
    s_cbranch_scc1 opq_w8end
    s_lshl_b32 s29, s12, 8
    s_add_u32 s20, s6, s29
    s_addc_u32 s21, s7, 0
    s_sub_u32 s22, 2457600, s29
    s_mov_b32 s23, 0x20000
    v_lshrrev_b32 v3, 4, v0
    v_lshrrev_b32 v4, 2, v0
    v_xor_b32 v4, v4, v3
    v_and_b32 v4, 3, v4
    v_and_b32 v5, 3, v0
    v_mul_u32_u24 v3, 3840, v3
    v_lshl_add_u32 v3, v4, 6, v3
    v_lshl_add_u32 v3, v5, 4, v3
    s_mov_b32 s30, 0
    s_mov_b32 s31, 0
    s_barrier
opq_w8loop:
    s_waitcnt vmcnt(59)
    s_add_u32 m0, s30, 0
    s_add_u32 s34, s31, 0
    buffer_load_dwordx4 v3, s[20:23], s34 offen lds
    s_add_u32 m0, s30, 1024
    s_add_u32 s34, s31, 15360
    buffer_load_dwordx4 v3, s[20:23], s34 offen lds
    s_add_u32 m0, s30, 2048
    s_add_u32 s34, s31, 30720
    buffer_load_dwordx4 v3, s[20:23], s34 offen lds
    s_add_u32 m0, s30, 3072
    s_add_u32 s34, s31, 46080
    buffer_load_dwordx4 v3, s[20:23], s34 offen lds
    s_add_u32 s30, s30, 4096
    s_add_u32 s31, s31, 61440
    s_cmp_lt_u32 s30, 45056
    s_cbranch_scc1 opq_w8loop
    s_barrier
    s_waitcnt vmcnt(0)
    s_barrier
opq_w8end:
    s_endpgm
opq_idle:
    s_waitcnt vmcnt(0)
    s_barrier
    s_cmp_lg_u32 s13, 0
    s_cbranch_scc1 opq_s3_sdone
    s_add_u32 s60, s8, s57
    s_addc_u32 s61, s9, 0
    s_mov_b32 s62, 65536
    s_mov_b32 s63, 0x20000
    v_lshlrev_b32 v1, 7, v0
    v_mov_b32 v167, 1
    s_mov_b32 exec_lo, 0x7fff
    s_mov_b32 exec_hi, 0
    buffer_store_dword v167, v1, s[60:63], s30 offen sc0 sc1
    s_mov_b64 exec, -1
opq_s3_sdone:
    s_branch opq_fin
opq_qcons:
    s_waitcnt vmcnt(0)
    s_barrier
    s_cmp_lg_u32 s13, 0
    s_cbranch_scc1 opq_s2_sdone
    s_add_u32 s60, s8, s57
    s_addc_u32 s61, s9, 0
    s_mov_b32 s62, 65536
    s_mov_b32 s63, 0x20000
    v_lshlrev_b32 v1, 7, v0
    v_mov_b32 v167, 1
    s_mov_b32 exec_lo, 0x7fff
    s_mov_b32 exec_hi, 0
    buffer_store_dword v167, v1, s[60:63], s30 offen sc0 sc1
    s_mov_b64 exec, -1
opq_s2_sdone:
    v_lshrrev_b32 v2, 5, v0
    v_and_b32 v3, 31, v0
    v_lshlrev_b32 v24, 4, v0
    s_lshl_b32 s40, s11, 2
    s_add_u32 s40, s40, s13
    s_mul_i32 s28, s40, 40960
    s_add_u32 s28, s28, s58
    s_add_u32 s16, s8, s28
    s_addc_u32 s17, s9, 0
    s_mov_b32 s18, 40960
    s_mov_b32 s19, 0x20000
    s_lshr_b32 s41, s40, 1
    s_lshl_b32 s41, s41, 12
    s_and_b32 s28, s40, 1
    s_lshl_b32 s28, s28, 8
    s_add_u32 s41, s41, s28
    s_cmp_lt_u32 s12, 10
    s_cselect_b64 s[44:45], -1, 0
    v_lshrrev_b32 v28, 2, v0
    v_and_b32 v28, 3, v28
    v_lshl_add_u32 v29, v2, 3, v28
    v_lshlrev_b32 v29, 8, v29
    v_and_b32 v30, 16, v0
    v_lshl_add_u32 v29, v30, 1, v29
    v_and_b32 v30, 3, v0
    v_lshlrev_b32 v30, 3, v30
    v_and_b32 v31, 1, v0
    v_lshlrev_b32 v31, 4, v31
    v_and_b32 v32, 2, v0
    v_lshl_add_u32 v31, v32, 2, v31
    v_cndmask_b32 v30, v30, v31, s[44:45]
    v_add_u32 v29, v29, v30
    v_lshl_add_u32 v4, v28, 6, v29
    v_xor_b32 v5, 64, v4
    v_xor_b32 v6, 128, v4
    v_xor_b32 v7, 192, v4
    v_and_b32 v28, 0x13, v0
    v_and_b32 v29, 4, v0
    v_lshl_add_u32 v28, v29, 1, v28
    v_and_b32 v29, 8, v0
    v_lshrrev_b32 v29, 1, v29
    v_add_u32 v28, v28, v29
    v_cndmask_b32 v27, v3, v28, s[44:45]
    v_lshlrev_b32 v27, 3, v27
    s_lshl_b32 s36, s12, 10
    s_add_u32 s36, s36, s56
    s_mov_b32 s20, s8
    s_mov_b32 s21, s9
    s_mov_b32 s22, 0x1000000
    s_mov_b32 s23, 0x20000
    s_mov_b32 s37, 0
    s_mov_b32 s27, 0x20000
    v_mov_b32 v100, 0
    v_mov_b32 v101, 0
    v_mov_b32 v102, 0
    v_mov_b32 v103, 0
    v_mov_b32 v104, 0
    v_mov_b32 v105, 0
    v_mov_b32 v106, 0
    v_mov_b32 v107, 0
    v_mov_b32 v108, 0
    v_mov_b32 v109, 0
    v_mov_b32 v110, 0
    v_mov_b32 v111, 0
    v_mov_b32 v112, 0
    v_mov_b32 v113, 0
    v_mov_b32 v114, 0
    v_mov_b32 v115, 0
    v_mov_b32 v116, 0
    v_mov_b32 v117, 0
    v_mov_b32 v118, 0
    v_mov_b32 v119, 0
    v_mov_b32 v120, 0
    v_mov_b32 v121, 0
    v_mov_b32 v122, 0
    v_mov_b32 v123, 0
    v_mov_b32 v124, 0
    v_mov_b32 v125, 0
    v_mov_b32 v126, 0
    v_mov_b32 v127, 0
    v_mov_b32 v128, 0
    v_mov_b32 v129, 0
    v_mov_b32 v130, 0
    v_mov_b32 v131, 0
    v_mov_b32 v132, 0
    v_mov_b32 v133, 0
    v_mov_b32 v134, 0
    v_mov_b32 v135, 0
    v_mov_b32 v136, 0
    v_mov_b32 v137, 0
    v_mov_b32 v138, 0
    v_mov_b32 v139, 0
    v_mov_b32 v140, 0
    v_mov_b32 v141, 0
    v_mov_b32 v142, 0
    v_mov_b32 v143, 0
    v_mov_b32 v144, 0
    v_mov_b32 v145, 0
    v_mov_b32 v146, 0
    v_mov_b32 v147, 0
    v_mov_b32 v148, 0
    v_mov_b32 v149, 0
    v_mov_b32 v150, 0
    v_mov_b32 v151, 0
    v_mov_b32 v152, 0
    v_mov_b32 v153, 0
    v_mov_b32 v154, 0
    v_mov_b32 v155, 0
    v_mov_b32 v156, 0
    v_mov_b32 v157, 0
    v_mov_b32 v158, 0
    v_mov_b32 v159, 0
    v_mov_b32 v160, 0
    v_mov_b32 v161, 0
    v_mov_b32 v162, 0
    v_mov_b32 v163, 0
    s_cmp_ge_u32 s12, 10
    s_cbranch_scc1 opq_v_setup
    s_mov_b32 s42, 81920
    s_mov_b32 s43, 1280
    s_mov_b32 s30, 1024
    s_mov_b32 s28, 5242880
    s_mov_b32 s26, 2621440
    s_cmp_ge_u32 s12, 5
    s_cmov_b32 s42, 163840
    s_cmov_b32 s43, 2560
    s_cmov_b32 s30, 2304
    s_cmov_b32 s28, 7864320
    s_cmov_b32 s26, 5242880
    s_cselect_b32 s29, 5, 0
    s_add_u32 s28, s28, s58
    s_add_u32 s24, s8, s28
    s_addc_u32 s25, s9, 0
    s_sub_u32 s29, s12, s29
    s_mul_i32 s40, s40, s43
    s_add_u32 s43, s40, s42
    s_lshl_b32 s29, s29, 4
    v_lshlrev_b32 v30, 4, v3
    v_lshlrev_b32 v31, 3, v3
    v_add_u32 v31, s30, v31
    v_mov_b32 v32, 0x7fffff00
    s_mov_b32 s14, 0
    s_add_u32 s30, s29, 0
    v_add_u32 v28, s30, v2
    v_mul_u32_u24 v29, 205, v28
    v_lshrrev_b32 v29, 10, v29
    v_mul_u32_u24 v33, 5, v29
    v_sub_u32 v28, v28, v33
    v_cmp_eq_u32 s[46:47], 2, v28
    v_cmp_lt_u32 s[44:45], 2, v28
    v_lshlrev_b32 v29, 1, v29
    v_mul_lo_u32 v29, v29, s42
    v_add_u32 v34, v29, v31
    v_cndmask_b32 v9, v32, v34, s[46:47]
    v_mov_b32 v33, 0
    v_mov_b32 v34, s42
    v_cndmask_b32 v33, v33, v34, s[44:45]
    v_add_u32 v29, v29, v33
    v_subrev_u32 v33, 3, v28
    v_cndmask_b32 v28, v28, v33, s[44:45]
    v_lshl_add_u32 v28, v28, 9, v30
    v_add_u32 v28, v28, v29
    v_cndmask_b32 v8, v28, v32, s[46:47]
    s_cmp_lg_u64 s[46:47], 0
    s_cselect_b32 s15, 1, 0
    s_or_b32 s14, s14, s15
    s_add_u32 s30, s29, 2
    v_add_u32 v28, s30, v2
    v_mul_u32_u24 v29, 205, v28
    v_lshrrev_b32 v29, 10, v29
    v_mul_u32_u24 v33, 5, v29
    v_sub_u32 v28, v28, v33
    v_cmp_eq_u32 s[46:47], 2, v28
    v_cmp_lt_u32 s[44:45], 2, v28
    v_lshlrev_b32 v29, 1, v29
    v_mul_lo_u32 v29, v29, s42
    v_add_u32 v34, v29, v31
    v_cndmask_b32 v11, v32, v34, s[46:47]
    v_mov_b32 v33, 0
    v_mov_b32 v34, s42
    v_cndmask_b32 v33, v33, v34, s[44:45]
    v_add_u32 v29, v29, v33
    v_subrev_u32 v33, 3, v28
    v_cndmask_b32 v28, v28, v33, s[44:45]
    v_lshl_add_u32 v28, v28, 9, v30
    v_add_u32 v28, v28, v29
    v_cndmask_b32 v10, v28, v32, s[46:47]
    s_cmp_lg_u64 s[46:47], 0
    s_cselect_b32 s15, 2, 0
    s_or_b32 s14, s14, s15
    s_add_u32 s30, s29, 4
    v_add_u32 v28, s30, v2
    v_mul_u32_u24 v29, 205, v28
    v_lshrrev_b32 v29, 10, v29
    v_mul_u32_u24 v33, 5, v29
    v_sub_u32 v28, v28, v33
    v_cmp_eq_u32 s[46:47], 2, v28
    v_cmp_lt_u32 s[44:45], 2, v28
    v_lshlrev_b32 v29, 1, v29
    v_mul_lo_u32 v29, v29, s42
    v_add_u32 v34, v29, v31
    v_cndmask_b32 v13, v32, v34, s[46:47]
    v_mov_b32 v33, 0
    v_mov_b32 v34, s42
    v_cndmask_b32 v33, v33, v34, s[44:45]
    v_add_u32 v29, v29, v33
    v_subrev_u32 v33, 3, v28
    v_cndmask_b32 v28, v28, v33, s[44:45]
    v_lshl_add_u32 v28, v28, 9, v30
    v_add_u32 v28, v28, v29
    v_cndmask_b32 v12, v28, v32, s[46:47]
    s_cmp_lg_u64 s[46:47], 0
    s_cselect_b32 s15, 4, 0
    s_or_b32 s14, s14, s15
    s_add_u32 s30, s29, 6
    v_add_u32 v28, s30, v2
    v_mul_u32_u24 v29, 205, v28
    v_lshrrev_b32 v29, 10, v29
    v_mul_u32_u24 v33, 5, v29
    v_sub_u32 v28, v28, v33
    v_cmp_eq_u32 s[46:47], 2, v28
    v_cmp_lt_u32 s[44:45], 2, v28
    v_lshlrev_b32 v29, 1, v29
    v_mul_lo_u32 v29, v29, s42
    v_add_u32 v34, v29, v31
    v_cndmask_b32 v15, v32, v34, s[46:47]
    v_mov_b32 v33, 0
    v_mov_b32 v34, s42
    v_cndmask_b32 v33, v33, v34, s[44:45]
    v_add_u32 v29, v29, v33
    v_subrev_u32 v33, 3, v28
    v_cndmask_b32 v28, v28, v33, s[44:45]
    v_lshl_add_u32 v28, v28, 9, v30
    v_add_u32 v28, v28, v29
    v_cndmask_b32 v14, v28, v32, s[46:47]
    s_cmp_lg_u64 s[46:47], 0
    s_cselect_b32 s15, 8, 0
    s_or_b32 s14, s14, s15
    s_add_u32 s30, s29, 8
    v_add_u32 v28, s30, v2
    v_mul_u32_u24 v29, 205, v28
    v_lshrrev_b32 v29, 10, v29
    v_mul_u32_u24 v33, 5, v29
    v_sub_u32 v28, v28, v33
    v_cmp_eq_u32 s[46:47], 2, v28
    v_cmp_lt_u32 s[44:45], 2, v28
    v_lshlrev_b32 v29, 1, v29
    v_mul_lo_u32 v29, v29, s42
    v_add_u32 v34, v29, v31
    v_cndmask_b32 v17, v32, v34, s[46:47]
    v_mov_b32 v33, 0
    v_mov_b32 v34, s42
    v_cndmask_b32 v33, v33, v34, s[44:45]
    v_add_u32 v29, v29, v33
    v_subrev_u32 v33, 3, v28
    v_cndmask_b32 v28, v28, v33, s[44:45]
    v_lshl_add_u32 v28, v28, 9, v30
    v_add_u32 v28, v28, v29
    v_cndmask_b32 v16, v28, v32, s[46:47]
    s_cmp_lg_u64 s[46:47], 0
    s_cselect_b32 s15, 16, 0
    s_or_b32 s14, s14, s15
    s_add_u32 s30, s29, 10
    v_add_u32 v28, s30, v2
    v_mul_u32_u24 v29, 205, v28
    v_lshrrev_b32 v29, 10, v29
    v_mul_u32_u24 v33, 5, v29
    v_sub_u32 v28, v28, v33
    v_cmp_eq_u32 s[46:47], 2, v28
    v_cmp_lt_u32 s[44:45], 2, v28
    v_lshlrev_b32 v29, 1, v29
    v_mul_lo_u32 v29, v29, s42
    v_add_u32 v34, v29, v31
    v_cndmask_b32 v19, v32, v34, s[46:47]
    v_mov_b32 v33, 0
    v_mov_b32 v34, s42
    v_cndmask_b32 v33, v33, v34, s[44:45]
    v_add_u32 v29, v29, v33
    v_subrev_u32 v33, 3, v28
    v_cndmask_b32 v28, v28, v33, s[44:45]
    v_lshl_add_u32 v28, v28, 9, v30
    v_add_u32 v28, v28, v29
    v_cndmask_b32 v18, v28, v32, s[46:47]
    s_cmp_lg_u64 s[46:47], 0
    s_cselect_b32 s15, 32, 0
    s_or_b32 s14, s14, s15
    s_add_u32 s30, s29, 12
    v_add_u32 v28, s30, v2
    v_mul_u32_u24 v29, 205, v28
    v_lshrrev_b32 v29, 10, v29
    v_mul_u32_u24 v33, 5, v29
    v_sub_u32 v28, v28, v33
    v_cmp_eq_u32 s[46:47], 2, v28
    v_cmp_lt_u32 s[44:45], 2, v28
    v_lshlrev_b32 v29, 1, v29
    v_mul_lo_u32 v29, v29, s42
    v_add_u32 v34, v29, v31
    v_cndmask_b32 v21, v32, v34, s[46:47]
    v_mov_b32 v33, 0
    v_mov_b32 v34, s42
    v_cndmask_b32 v33, v33, v34, s[44:45]
    v_add_u32 v29, v29, v33
    v_subrev_u32 v33, 3, v28
    v_cndmask_b32 v28, v28, v33, s[44:45]
    v_lshl_add_u32 v28, v28, 9, v30
    v_add_u32 v28, v28, v29
    v_cndmask_b32 v20, v28, v32, s[46:47]
    s_cmp_lg_u64 s[46:47], 0
    s_cselect_b32 s15, 64, 0
    s_or_b32 s14, s14, s15
    s_add_u32 s30, s29, 14
    v_add_u32 v28, s30, v2
    v_mul_u32_u24 v29, 205, v28
    v_lshrrev_b32 v29, 10, v29
    v_mul_u32_u24 v33, 5, v29
    v_sub_u32 v28, v28, v33
    v_cmp_eq_u32 s[46:47], 2, v28
    v_cmp_lt_u32 s[44:45], 2, v28
    v_lshlrev_b32 v29, 1, v29
    v_mul_lo_u32 v29, v29, s42
    v_add_u32 v34, v29, v31
    v_cndmask_b32 v23, v32, v34, s[46:47]
    v_mov_b32 v33, 0
    v_mov_b32 v34, s42
    v_cndmask_b32 v33, v33, v34, s[44:45]
    v_add_u32 v29, v29, v33
    v_subrev_u32 v33, 3, v28
    v_cndmask_b32 v28, v28, v33, s[44:45]
    v_lshl_add_u32 v28, v28, 9, v30
    v_add_u32 v28, v28, v29
    v_cndmask_b32 v22, v28, v32, s[46:47]
    s_cmp_lg_u64 s[46:47], 0
    s_cselect_b32 s15, 128, 0
    s_or_b32 s14, s14, s15
    s_cmp_lg_u32 s13, 0
    s_cbranch_scc1 opq_s2qk_done
    s_add_u32 s60, s8, s57
    s_addc_u32 s61, s9, 0
    s_mov_b32 s62, 65536
    s_mov_b32 s63, 0x20000
    v_lshlrev_b32 v1, 2, v0
    s_mov_b32 exec_lo, 0xffff
    s_mov_b32 exec_hi, 0
    s_mov_b32 s3, 0
opq_s2qk_poll:
    buffer_load_dword v164, v1, s[60:63], s31 offen sc0 sc1
    s_add_u32 s3, s3, 1
    s_waitcnt vmcnt(0)
    v_cmp_eq_u32 vcc, 0, v164
    s_cbranch_vccz opq_s2qk_out
    s_cmp_lt_u32 s3, 0x400000
    s_cbranch_scc1 opq_s2qk_poll
opq_s2qk_out:
    s_mov_b64 exec, -1
opq_s2qk_done:
    s_barrier
    s_mov_b32 s28, 0
    buffer_load_dwordx4 v[28:31], v24, s[16:19], s28 offen offset:0 sc1
    buffer_load_dwordx4 v[32:35], v24, s[16:19], s28 offen offset:1024 sc1
    buffer_load_dwordx4 v[36:39], v24, s[16:19], s28 offen offset:2048 sc1
    buffer_load_dwordx4 v[40:43], v24, s[16:19], s28 offen offset:3072 sc1
    s_mov_b32 s28, 4096
    buffer_load_dwordx4 v[44:47], v24, s[16:19], s28 offen offset:0 sc1
    buffer_load_dwordx4 v[48:51], v24, s[16:19], s28 offen offset:1024 sc1
    buffer_load_dwordx4 v[52:55], v24, s[16:19], s28 offen offset:2048 sc1
    buffer_load_dwordx4 v[56:59], v24, s[16:19], s28 offen offset:3072 sc1
    s_mov_b32 s28, 8192
    buffer_load_dwordx4 v[60:63], v24, s[16:19], s28 offen offset:0 sc1
    buffer_load_dwordx4 v[64:67], v24, s[16:19], s28 offen offset:1024 sc1
    s_mov_b32 s39, 10240
    ds_read_b64_tr_b16 v[68:69], v4 offset:0
    ds_read_b64_tr_b16 v[70:71], v4 offset:1024
    ds_read_b64_tr_b16 v[72:73], v5 offset:0
    ds_read_b64_tr_b16 v[74:75], v5 offset:1024
    ds_read_b64_tr_b16 v[76:77], v6 offset:0
    ds_read_b64_tr_b16 v[78:79], v6 offset:1024
    ds_read_b64_tr_b16 v[80:81], v7 offset:0
    ds_read_b64_tr_b16 v[82:83], v7 offset:1024
    s_mov_b32 s50, -1
    s_mov_b32 s51, 0
    s_lshl_b32 s29, s13, 7
    s_waitcnt vmcnt(10)
    v_lshl_add_u32 v164, v3, 2, s29
    v_lshl_add_u32 v165, v2, 4, s29
opq_qloop_qk:
    s_waitcnt vmcnt(9) lgkmcnt(6)
    v_mfma_f32_32x32x16_bf16 v[100:115], v[68:71], v[28:31], v[100:115]
    ds_read_b64_tr_b16 v[84:85], v4 offset:4096
    ds_read_b64_tr_b16 v[86:87], v4 offset:5120
    s_waitcnt lgkmcnt(6)
    v_mfma_f32_32x32x16_bf16 v[116:131], v[72:75], v[28:31], v[116:131]
    ds_read_b64_tr_b16 v[88:89], v5 offset:4096
    ds_read_b64_tr_b16 v[90:91], v5 offset:5120
    s_waitcnt lgkmcnt(6)
    v_mfma_f32_32x32x16_bf16 v[132:147], v[76:79], v[28:31], v[132:147]
    ds_read_b64_tr_b16 v[92:93], v6 offset:4096
    ds_read_b64_tr_b16 v[94:95], v6 offset:5120
    s_waitcnt lgkmcnt(6)
    v_mfma_f32_32x32x16_bf16 v[148:163], v[80:83], v[28:31], v[148:163]
    ds_read_b64_tr_b16 v[96:97], v7 offset:4096
    ds_read_b64_tr_b16 v[98:99], v7 offset:5120
    s_add_u32 s28, s39, 0
    buffer_load_dwordx4 v[28:31], v24, s[16:19], s28 offen offset:0 sc1
    s_waitcnt vmcnt(9) lgkmcnt(6)
    v_mfma_f32_32x32x16_bf16 v[100:115], v[84:87], v[32:35], v[100:115]
    ds_read_b64_tr_b16 v[68:69], v4 offset:8192
    ds_read_b64_tr_b16 v[70:71], v4 offset:9216
    s_waitcnt lgkmcnt(6)
    v_mfma_f32_32x32x16_bf16 v[116:131], v[88:91], v[32:35], v[116:131]
    ds_read_b64_tr_b16 v[72:73], v5 offset:8192
    ds_read_b64_tr_b16 v[74:75], v5 offset:9216
    s_waitcnt lgkmcnt(6)
    v_mfma_f32_32x32x16_bf16 v[132:147], v[92:95], v[32:35], v[132:147]
    ds_read_b64_tr_b16 v[76:77], v6 offset:8192
    ds_read_b64_tr_b16 v[78:79], v6 offset:9216
    s_waitcnt lgkmcnt(6)
    v_mfma_f32_32x32x16_bf16 v[148:163], v[96:99], v[32:35], v[148:163]
    ds_read_b64_tr_b16 v[80:81], v7 offset:8192
    ds_read_b64_tr_b16 v[82:83], v7 offset:9216
    buffer_load_dwordx4 v[32:35], v24, s[16:19], s28 offen offset:1024 sc1
    s_waitcnt vmcnt(9) lgkmcnt(6)
    v_mfma_f32_32x32x16_bf16 v[100:115], v[68:71], v[36:39], v[100:115]
    ds_read_b64_tr_b16 v[84:85], v4 offset:12288
    ds_read_b64_tr_b16 v[86:87], v4 offset:13312
    s_waitcnt lgkmcnt(6)
    v_mfma_f32_32x32x16_bf16 v[116:131], v[72:75], v[36:39], v[116:131]
    ds_read_b64_tr_b16 v[88:89], v5 offset:12288
    ds_read_b64_tr_b16 v[90:91], v5 offset:13312
    s_waitcnt lgkmcnt(6)
    v_mfma_f32_32x32x16_bf16 v[132:147], v[76:79], v[36:39], v[132:147]
    ds_read_b64_tr_b16 v[92:93], v6 offset:12288
    ds_read_b64_tr_b16 v[94:95], v6 offset:13312
    s_waitcnt lgkmcnt(6)
    v_mfma_f32_32x32x16_bf16 v[148:163], v[80:83], v[36:39], v[148:163]
    ds_read_b64_tr_b16 v[96:97], v7 offset:12288
    ds_read_b64_tr_b16 v[98:99], v7 offset:13312
    buffer_load_dwordx4 v[36:39], v24, s[16:19], s28 offen offset:2048 sc1
    s_waitcnt vmcnt(9) lgkmcnt(6)
    v_mfma_f32_32x32x16_bf16 v[100:115], v[84:87], v[40:43], v[100:115]
    ds_read_b64_tr_b16 v[68:69], v4 offset:16384
    ds_read_b64_tr_b16 v[70:71], v4 offset:17408
    s_waitcnt lgkmcnt(6)
    v_mfma_f32_32x32x16_bf16 v[116:131], v[88:91], v[40:43], v[116:131]
    ds_read_b64_tr_b16 v[72:73], v5 offset:16384
    ds_read_b64_tr_b16 v[74:75], v5 offset:17408
    s_waitcnt lgkmcnt(6)
    v_mfma_f32_32x32x16_bf16 v[132:147], v[92:95], v[40:43], v[132:147]
    ds_read_b64_tr_b16 v[76:77], v6 offset:16384
    ds_read_b64_tr_b16 v[78:79], v6 offset:17408
    s_waitcnt lgkmcnt(6)
    v_mfma_f32_32x32x16_bf16 v[148:163], v[96:99], v[40:43], v[148:163]
    ds_read_b64_tr_b16 v[80:81], v7 offset:16384
    ds_read_b64_tr_b16 v[82:83], v7 offset:17408
    buffer_load_dwordx4 v[40:43], v24, s[16:19], s28 offen offset:3072 sc1
    s_waitcnt vmcnt(9) lgkmcnt(6)
    v_mfma_f32_32x32x16_bf16 v[100:115], v[68:71], v[44:47], v[100:115]
    ds_read_b64_tr_b16 v[84:85], v4 offset:20480
    ds_read_b64_tr_b16 v[86:87], v4 offset:21504
    s_waitcnt lgkmcnt(6)
    v_mfma_f32_32x32x16_bf16 v[116:131], v[72:75], v[44:47], v[116:131]
    ds_read_b64_tr_b16 v[88:89], v5 offset:20480
    ds_read_b64_tr_b16 v[90:91], v5 offset:21504
    s_waitcnt lgkmcnt(6)
    v_mfma_f32_32x32x16_bf16 v[132:147], v[76:79], v[44:47], v[132:147]
    ds_read_b64_tr_b16 v[92:93], v6 offset:20480
    ds_read_b64_tr_b16 v[94:95], v6 offset:21504
    s_waitcnt lgkmcnt(6)
    v_mfma_f32_32x32x16_bf16 v[148:163], v[80:83], v[44:47], v[148:163]
    ds_read_b64_tr_b16 v[96:97], v7 offset:20480
    ds_read_b64_tr_b16 v[98:99], v7 offset:21504
    s_add_u32 s28, s39, 4096
    buffer_load_dwordx4 v[44:47], v24, s[16:19], s28 offen offset:0 sc1
    s_waitcnt vmcnt(9) lgkmcnt(6)
    v_mfma_f32_32x32x16_bf16 v[100:115], v[84:87], v[48:51], v[100:115]
    ds_read_b64_tr_b16 v[68:69], v4 offset:24576
    ds_read_b64_tr_b16 v[70:71], v4 offset:25600
    s_waitcnt lgkmcnt(6)
    v_mfma_f32_32x32x16_bf16 v[116:131], v[88:91], v[48:51], v[116:131]
    ds_read_b64_tr_b16 v[72:73], v5 offset:24576
    ds_read_b64_tr_b16 v[74:75], v5 offset:25600
    s_waitcnt lgkmcnt(6)
    v_mfma_f32_32x32x16_bf16 v[132:147], v[92:95], v[48:51], v[132:147]
    ds_read_b64_tr_b16 v[76:77], v6 offset:24576
    ds_read_b64_tr_b16 v[78:79], v6 offset:25600
    s_waitcnt lgkmcnt(6)
    v_mfma_f32_32x32x16_bf16 v[148:163], v[96:99], v[48:51], v[148:163]
    ds_read_b64_tr_b16 v[80:81], v7 offset:24576
    ds_read_b64_tr_b16 v[82:83], v7 offset:25600
    buffer_load_dwordx4 v[48:51], v24, s[16:19], s28 offen offset:1024 sc1
    s_waitcnt vmcnt(9) lgkmcnt(6)
    v_mfma_f32_32x32x16_bf16 v[100:115], v[68:71], v[52:55], v[100:115]
    ds_read_b64_tr_b16 v[84:85], v4 offset:28672
    ds_read_b64_tr_b16 v[86:87], v4 offset:29696
    s_waitcnt lgkmcnt(6)
    v_mfma_f32_32x32x16_bf16 v[116:131], v[72:75], v[52:55], v[116:131]
    ds_read_b64_tr_b16 v[88:89], v5 offset:28672
    ds_read_b64_tr_b16 v[90:91], v5 offset:29696
    s_waitcnt lgkmcnt(6)
    v_mfma_f32_32x32x16_bf16 v[132:147], v[76:79], v[52:55], v[132:147]
    ds_read_b64_tr_b16 v[92:93], v6 offset:28672
    ds_read_b64_tr_b16 v[94:95], v6 offset:29696
    s_waitcnt lgkmcnt(6)
    v_mfma_f32_32x32x16_bf16 v[148:163], v[80:83], v[52:55], v[148:163]
    ds_read_b64_tr_b16 v[96:97], v7 offset:28672
    ds_read_b64_tr_b16 v[98:99], v7 offset:29696
    buffer_load_dwordx4 v[52:55], v24, s[16:19], s28 offen offset:2048 sc1
    s_waitcnt vmcnt(9) lgkmcnt(6)
    v_mfma_f32_32x32x16_bf16 v[100:115], v[84:87], v[56:59], v[100:115]
    ds_read_b64_tr_b16 v[68:69], v4 offset:32768
    ds_read_b64_tr_b16 v[70:71], v4 offset:33792
    s_waitcnt lgkmcnt(6)
    v_mfma_f32_32x32x16_bf16 v[116:131], v[88:91], v[56:59], v[116:131]
    ds_read_b64_tr_b16 v[72:73], v5 offset:32768
    ds_read_b64_tr_b16 v[74:75], v5 offset:33792
    s_waitcnt lgkmcnt(6)
    v_mfma_f32_32x32x16_bf16 v[132:147], v[92:95], v[56:59], v[132:147]
    ds_read_b64_tr_b16 v[76:77], v6 offset:32768
    ds_read_b64_tr_b16 v[78:79], v6 offset:33792
    s_waitcnt lgkmcnt(6)
    v_mfma_f32_32x32x16_bf16 v[148:163], v[96:99], v[56:59], v[148:163]
    ds_read_b64_tr_b16 v[80:81], v7 offset:32768
    ds_read_b64_tr_b16 v[82:83], v7 offset:33792
    buffer_load_dwordx4 v[56:59], v24, s[16:19], s28 offen offset:3072 sc1
    s_waitcnt vmcnt(9) lgkmcnt(6)
    v_mfma_f32_32x32x16_bf16 v[100:115], v[68:71], v[60:63], v[100:115]
    ds_read_b64_tr_b16 v[84:85], v4 offset:36864
    ds_read_b64_tr_b16 v[86:87], v4 offset:37888
    s_waitcnt lgkmcnt(6)
    v_mfma_f32_32x32x16_bf16 v[116:131], v[72:75], v[60:63], v[116:131]
    ds_read_b64_tr_b16 v[88:89], v5 offset:36864
    ds_read_b64_tr_b16 v[90:91], v5 offset:37888
    s_waitcnt lgkmcnt(6)
    v_mfma_f32_32x32x16_bf16 v[132:147], v[76:79], v[60:63], v[132:147]
    ds_read_b64_tr_b16 v[92:93], v6 offset:36864
    ds_read_b64_tr_b16 v[94:95], v6 offset:37888
    s_waitcnt lgkmcnt(6)
    v_mfma_f32_32x32x16_bf16 v[148:163], v[80:83], v[60:63], v[148:163]
    ds_read_b64_tr_b16 v[96:97], v7 offset:36864
    ds_read_b64_tr_b16 v[98:99], v7 offset:37888
    s_add_u32 s28, s39, 8192
    buffer_load_dwordx4 v[60:63], v24, s[16:19], s28 offen offset:0 sc1
    s_waitcnt vmcnt(9) lgkmcnt(6)
    v_mfma_f32_32x32x16_bf16 v[100:115], v[84:87], v[64:67], v[100:115]
    ds_read_b64_tr_b16 v[68:69], v4 offset:40960
    ds_read_b64_tr_b16 v[70:71], v4 offset:41984
    s_waitcnt lgkmcnt(6)
    v_mfma_f32_32x32x16_bf16 v[116:131], v[88:91], v[64:67], v[116:131]
    ds_read_b64_tr_b16 v[72:73], v5 offset:40960
    ds_read_b64_tr_b16 v[74:75], v5 offset:41984
    s_waitcnt lgkmcnt(6)
    v_mfma_f32_32x32x16_bf16 v[132:147], v[92:95], v[64:67], v[132:147]
    ds_read_b64_tr_b16 v[76:77], v6 offset:40960
    ds_read_b64_tr_b16 v[78:79], v6 offset:41984
    s_waitcnt lgkmcnt(6)
    v_mfma_f32_32x32x16_bf16 v[148:163], v[96:99], v[64:67], v[148:163]
    ds_read_b64_tr_b16 v[80:81], v7 offset:40960
    ds_read_b64_tr_b16 v[82:83], v7 offset:41984
    buffer_load_dwordx4 v[64:67], v24, s[16:19], s28 offen offset:1024 sc1
    v_add_u32 v4, 40960, v4
    v_add_u32 v5, 40960, v5
    v_add_u32 v6, 40960, v6
    v_add_u32 v7, 40960, v7
    s_add_u32 s39, s39, 10240
    s_add_u32 s37, s37, 1
    s_bitcmp1_b32 s37, 0
    s_cbranch_scc0 opq_qnb_qk
    s_barrier
opq_qnb_qk:
    s_cmp_lt_u32 s37, 4
    s_cbranch_scc1 opq_qloop_qk
    s_waitcnt vmcnt(0) lgkmcnt(0)
    ds_read_b32 v26, v164 offset:512
    ds_read_b64 v[40:41], v27 offset:1024
    ds_read_b64 v[42:43], v27 offset:1280
    ds_read_b64 v[44:45], v27 offset:1536
    ds_read_b64 v[46:47], v27 offset:1792
    ds_read_b32 v25, v164
    s_waitcnt lgkmcnt(5)
    v_mov_b32 v34, 0
    v_cndmask_b32 v34, v34, v26, s[50:51]
    v_lshrrev_b32 v37, 16, v34
    v_or_b32 v36, v37, v34
    s_waitcnt lgkmcnt(0)
    s_nop 0
    v_mfma_f32_32x32x8_bf16 v[100:115], v[40:41], v[36:37], v[100:115]
    v_mfma_f32_32x32x8_bf16 v[116:131], v[42:43], v[36:37], v[116:131]
    v_mfma_f32_32x32x8_bf16 v[132:147], v[44:45], v[36:37], v[132:147]
    v_mfma_f32_32x32x8_bf16 v[148:163], v[46:47], v[36:37], v[148:163]
    s_nop 8
    v_mul_f32 v48, v25, v100
    v_mul_f32 v49, v25, v101
    v_mul_f32 v50, v25, v102
    v_mul_f32 v51, v25, v103
    v_mul_f32 v52, v25, v104
    v_mul_f32 v53, v25, v105
    v_mul_f32 v54, v25, v106
    v_mul_f32 v55, v25, v107
    v_cvt_pk_bf16_f32 v56, v48, v49
    v_cvt_pk_bf16_f32 v57, v50, v51
    v_cvt_pk_bf16_f32 v58, v52, v53
    v_cvt_pk_bf16_f32 v59, v54, v55
    buffer_store_dwordx4 v[56:59], v8, s[24:27], s40 offen sc0 sc1
    s_bitcmp1_b32 s14, 0
    s_cbranch_scc0 opq_ns0
    buffer_store_dwordx2 v[56:57], v9, s[24:27], s40 offen sc0 sc1
    buffer_store_dwordx2 v[58:59], v9, s[24:27], s43 offen sc0 sc1
opq_ns0:
    v_mul_f32 v68, v25, v108
    v_mul_f32 v69, v25, v109
    v_mul_f32 v70, v25, v110
    v_mul_f32 v71, v25, v111
    v_mul_f32 v72, v25, v112
    v_mul_f32 v73, v25, v113
    v_mul_f32 v74, v25, v114
    v_mul_f32 v75, v25, v115
    v_cvt_pk_bf16_f32 v76, v68, v69
    v_cvt_pk_bf16_f32 v77, v70, v71
    v_cvt_pk_bf16_f32 v78, v72, v73
    v_cvt_pk_bf16_f32 v79, v74, v75
    buffer_store_dwordx4 v[76:79], v10, s[24:27], s40 offen sc0 sc1
    s_bitcmp1_b32 s14, 1
    s_cbranch_scc0 opq_ns1
    buffer_store_dwordx2 v[76:77], v11, s[24:27], s40 offen sc0 sc1
    buffer_store_dwordx2 v[78:79], v11, s[24:27], s43 offen sc0 sc1
opq_ns1:
    v_mul_f32 v48, v25, v116
    v_mul_f32 v49, v25, v117
    v_mul_f32 v50, v25, v118
    v_mul_f32 v51, v25, v119
    v_mul_f32 v52, v25, v120
    v_mul_f32 v53, v25, v121
    v_mul_f32 v54, v25, v122
    v_mul_f32 v55, v25, v123
    v_cvt_pk_bf16_f32 v56, v48, v49
    v_cvt_pk_bf16_f32 v57, v50, v51
    v_cvt_pk_bf16_f32 v58, v52, v53
    v_cvt_pk_bf16_f32 v59, v54, v55
    buffer_store_dwordx4 v[56:59], v12, s[24:27], s40 offen sc0 sc1
    s_bitcmp1_b32 s14, 2
    s_cbranch_scc0 opq_ns2
    buffer_store_dwordx2 v[56:57], v13, s[24:27], s40 offen sc0 sc1
    buffer_store_dwordx2 v[58:59], v13, s[24:27], s43 offen sc0 sc1
opq_ns2:
    v_mul_f32 v68, v25, v124
    v_mul_f32 v69, v25, v125
    v_mul_f32 v70, v25, v126
    v_mul_f32 v71, v25, v127
    v_mul_f32 v72, v25, v128
    v_mul_f32 v73, v25, v129
    v_mul_f32 v74, v25, v130
    v_mul_f32 v75, v25, v131
    v_cvt_pk_bf16_f32 v76, v68, v69
    v_cvt_pk_bf16_f32 v77, v70, v71
    v_cvt_pk_bf16_f32 v78, v72, v73
    v_cvt_pk_bf16_f32 v79, v74, v75
    buffer_store_dwordx4 v[76:79], v14, s[24:27], s40 offen sc0 sc1
    s_bitcmp1_b32 s14, 3
    s_cbranch_scc0 opq_ns3
    buffer_store_dwordx2 v[76:77], v15, s[24:27], s40 offen sc0 sc1
    buffer_store_dwordx2 v[78:79], v15, s[24:27], s43 offen sc0 sc1
opq_ns3:
    v_mul_f32 v48, v25, v132
    v_mul_f32 v49, v25, v133
    v_mul_f32 v50, v25, v134
    v_mul_f32 v51, v25, v135
    v_mul_f32 v52, v25, v136
    v_mul_f32 v53, v25, v137
    v_mul_f32 v54, v25, v138
    v_mul_f32 v55, v25, v139
    v_cvt_pk_bf16_f32 v56, v48, v49
    v_cvt_pk_bf16_f32 v57, v50, v51
    v_cvt_pk_bf16_f32 v58, v52, v53
    v_cvt_pk_bf16_f32 v59, v54, v55
    buffer_store_dwordx4 v[56:59], v16, s[24:27], s40 offen sc0 sc1
    s_bitcmp1_b32 s14, 4
    s_cbranch_scc0 opq_ns4
    buffer_store_dwordx2 v[56:57], v17, s[24:27], s40 offen sc0 sc1
    buffer_store_dwordx2 v[58:59], v17, s[24:27], s43 offen sc0 sc1
opq_ns4:
    v_mul_f32 v68, v25, v140
    v_mul_f32 v69, v25, v141
    v_mul_f32 v70, v25, v142
    v_mul_f32 v71, v25, v143
    v_mul_f32 v72, v25, v144
    v_mul_f32 v73, v25, v145
    v_mul_f32 v74, v25, v146
    v_mul_f32 v75, v25, v147
    v_cvt_pk_bf16_f32 v76, v68, v69
    v_cvt_pk_bf16_f32 v77, v70, v71
    v_cvt_pk_bf16_f32 v78, v72, v73
    v_cvt_pk_bf16_f32 v79, v74, v75
    buffer_store_dwordx4 v[76:79], v18, s[24:27], s40 offen sc0 sc1
    s_bitcmp1_b32 s14, 5
    s_cbranch_scc0 opq_ns5
    buffer_store_dwordx2 v[76:77], v19, s[24:27], s40 offen sc0 sc1
    buffer_store_dwordx2 v[78:79], v19, s[24:27], s43 offen sc0 sc1
opq_ns5:
    v_mul_f32 v48, v25, v148
    v_mul_f32 v49, v25, v149
    v_mul_f32 v50, v25, v150
    v_mul_f32 v51, v25, v151
    v_mul_f32 v52, v25, v152
    v_mul_f32 v53, v25, v153
    v_mul_f32 v54, v25, v154
    v_mul_f32 v55, v25, v155
    v_cvt_pk_bf16_f32 v56, v48, v49
    v_cvt_pk_bf16_f32 v57, v50, v51
    v_cvt_pk_bf16_f32 v58, v52, v53
    v_cvt_pk_bf16_f32 v59, v54, v55
    buffer_store_dwordx4 v[56:59], v20, s[24:27], s40 offen sc0 sc1
    s_bitcmp1_b32 s14, 6
    s_cbranch_scc0 opq_ns6
    buffer_store_dwordx2 v[56:57], v21, s[24:27], s40 offen sc0 sc1
    buffer_store_dwordx2 v[58:59], v21, s[24:27], s43 offen sc0 sc1
opq_ns6:
    v_mul_f32 v68, v25, v156
    v_mul_f32 v69, v25, v157
    v_mul_f32 v70, v25, v158
    v_mul_f32 v71, v25, v159
    v_mul_f32 v72, v25, v160
    v_mul_f32 v73, v25, v161
    v_mul_f32 v74, v25, v162
    v_mul_f32 v75, v25, v163
    v_cvt_pk_bf16_f32 v76, v68, v69
    v_cvt_pk_bf16_f32 v77, v70, v71
    v_cvt_pk_bf16_f32 v78, v72, v73
    v_cvt_pk_bf16_f32 v79, v74, v75
    buffer_store_dwordx4 v[76:79], v22, s[24:27], s40 offen sc0 sc1
    s_bitcmp1_b32 s14, 7
    s_cbranch_scc0 opq_ns7
    buffer_store_dwordx2 v[76:77], v23, s[24:27], s40 offen sc0 sc1
    buffer_store_dwordx2 v[78:79], v23, s[24:27], s43 offen sc0 sc1
opq_ns7:
opq_fin:
    s_endpgm
opq_v_setup:
    s_add_u32 s28, s58, 7864320
    s_add_u32 s24, s8, s28
    s_addc_u32 s25, s9, 0
    s_mov_b32 s26, 5242880
    s_mul_i32 s40, s40, 2560
    s_sub_u32 s29, s12, 10
    s_lshl_b32 s29, s29, 7
    s_mov_b32 s42, 163840
    v_mul_u32_u24 v30, 320, v2
    v_add_u32 v30, 1024, v30
    s_add_u32 s28, s29, 0
    v_add_u32 v28, s28, v3
    v_mul_u32_u24 v29, 3277, v28
    v_lshrrev_b32 v29, 16, v29
    v_mul_u32_u24 v33, 20, v29
    v_sub_u32 v28, v28, v33
    v_lshl_add_u32 v28, v28, 4, v30
    v_mul_lo_u32 v29, v29, s42
    v_add_u32 v8, v29, v28
    s_add_u32 s28, s29, 32
    v_add_u32 v28, s28, v3
    v_mul_u32_u24 v29, 3277, v28
    v_lshrrev_b32 v29, 16, v29
    v_mul_u32_u24 v33, 20, v29
    v_sub_u32 v28, v28, v33
    v_lshl_add_u32 v28, v28, 4, v30
    v_mul_lo_u32 v29, v29, s42
    v_add_u32 v9, v29, v28
    s_add_u32 s28, s29, 64
    v_add_u32 v28, s28, v3
    v_mul_u32_u24 v29, 3277, v28
    v_lshrrev_b32 v29, 16, v29
    v_mul_u32_u24 v33, 20, v29
    v_sub_u32 v28, v28, v33
    v_lshl_add_u32 v28, v28, 4, v30
    v_mul_lo_u32 v29, v29, s42
    v_add_u32 v10, v29, v28
    s_add_u32 s28, s29, 96
    v_add_u32 v28, s28, v3
    v_mul_u32_u24 v29, 3277, v28
    v_lshrrev_b32 v29, 16, v29
    v_mul_u32_u24 v33, 20, v29
    v_sub_u32 v28, v28, v33
    v_lshl_add_u32 v28, v28, 4, v30
    v_mul_lo_u32 v29, v29, s42
    v_add_u32 v11, v29, v28
    s_cmp_lg_u32 s13, 0
    s_cbranch_scc1 opq_s2v_done
    s_add_u32 s60, s8, s57
    s_addc_u32 s61, s9, 0
    s_mov_b32 s62, 65536
    s_mov_b32 s63, 0x20000
    v_lshlrev_b32 v1, 2, v0
    s_mov_b32 exec_lo, 0xffff
    s_mov_b32 exec_hi, 0
    s_mov_b32 s3, 0
opq_s2v_poll:
    buffer_load_dword v164, v1, s[60:63], s31 offen sc0 sc1
    s_add_u32 s3, s3, 1
    s_waitcnt vmcnt(0)
    v_cmp_eq_u32 vcc, 0, v164
    s_cbranch_vccz opq_s2v_out
    s_cmp_lt_u32 s3, 0x400000
    s_cbranch_scc1 opq_s2v_poll
opq_s2v_out:
    s_mov_b64 exec, -1
opq_s2v_done:
    s_barrier
    s_mov_b32 s28, 0
    buffer_load_dwordx4 v[28:31], v24, s[16:19], s28 offen offset:0 sc1
    buffer_load_dwordx4 v[32:35], v24, s[16:19], s28 offen offset:1024 sc1
    buffer_load_dwordx4 v[36:39], v24, s[16:19], s28 offen offset:2048 sc1
    buffer_load_dwordx4 v[40:43], v24, s[16:19], s28 offen offset:3072 sc1
    s_mov_b32 s28, 4096
    buffer_load_dwordx4 v[44:47], v24, s[16:19], s28 offen offset:0 sc1
    buffer_load_dwordx4 v[48:51], v24, s[16:19], s28 offen offset:1024 sc1
    buffer_load_dwordx4 v[52:55], v24, s[16:19], s28 offen offset:2048 sc1
    buffer_load_dwordx4 v[56:59], v24, s[16:19], s28 offen offset:3072 sc1
    s_mov_b32 s28, 8192
    buffer_load_dwordx4 v[60:63], v24, s[16:19], s28 offen offset:0 sc1
    buffer_load_dwordx4 v[64:67], v24, s[16:19], s28 offen offset:1024 sc1
    s_mov_b32 s39, 10240
    ds_read_b64_tr_b16 v[68:69], v4 offset:0
    ds_read_b64_tr_b16 v[70:71], v4 offset:1024
    ds_read_b64_tr_b16 v[72:73], v5 offset:0
    ds_read_b64_tr_b16 v[74:75], v5 offset:1024
    ds_read_b64_tr_b16 v[76:77], v6 offset:0
    ds_read_b64_tr_b16 v[78:79], v6 offset:1024
    ds_read_b64_tr_b16 v[80:81], v7 offset:0
    ds_read_b64_tr_b16 v[82:83], v7 offset:1024
    s_mov_b32 s50, -1
    s_mov_b32 s51, 0
    s_lshl_b32 s29, s13, 7
    s_waitcnt vmcnt(10)
    v_lshl_add_u32 v164, v3, 2, s29
    v_lshl_add_u32 v165, v2, 4, s29
opq_qloop_v:
    s_waitcnt vmcnt(9) lgkmcnt(6)
    v_mfma_f32_32x32x16_bf16 v[100:115], v[28:31], v[68:71], v[100:115]
    ds_read_b64_tr_b16 v[84:85], v4 offset:4096
    ds_read_b64_tr_b16 v[86:87], v4 offset:5120
    s_waitcnt lgkmcnt(6)
    v_mfma_f32_32x32x16_bf16 v[116:131], v[28:31], v[72:75], v[116:131]
    ds_read_b64_tr_b16 v[88:89], v5 offset:4096
    ds_read_b64_tr_b16 v[90:91], v5 offset:5120
    s_waitcnt lgkmcnt(6)
    v_mfma_f32_32x32x16_bf16 v[132:147], v[28:31], v[76:79], v[132:147]
    ds_read_b64_tr_b16 v[92:93], v6 offset:4096
    ds_read_b64_tr_b16 v[94:95], v6 offset:5120
    s_waitcnt lgkmcnt(6)
    v_mfma_f32_32x32x16_bf16 v[148:163], v[28:31], v[80:83], v[148:163]
    ds_read_b64_tr_b16 v[96:97], v7 offset:4096
    ds_read_b64_tr_b16 v[98:99], v7 offset:5120
    s_add_u32 s28, s39, 0
    buffer_load_dwordx4 v[28:31], v24, s[16:19], s28 offen offset:0 sc1
    s_waitcnt vmcnt(9) lgkmcnt(6)
    v_mfma_f32_32x32x16_bf16 v[100:115], v[32:35], v[84:87], v[100:115]
    ds_read_b64_tr_b16 v[68:69], v4 offset:8192
    ds_read_b64_tr_b16 v[70:71], v4 offset:9216
    s_waitcnt lgkmcnt(6)
    v_mfma_f32_32x32x16_bf16 v[116:131], v[32:35], v[88:91], v[116:131]
    ds_read_b64_tr_b16 v[72:73], v5 offset:8192
    ds_read_b64_tr_b16 v[74:75], v5 offset:9216
    s_waitcnt lgkmcnt(6)
    v_mfma_f32_32x32x16_bf16 v[132:147], v[32:35], v[92:95], v[132:147]
    ds_read_b64_tr_b16 v[76:77], v6 offset:8192
    ds_read_b64_tr_b16 v[78:79], v6 offset:9216
    s_waitcnt lgkmcnt(6)
    v_mfma_f32_32x32x16_bf16 v[148:163], v[32:35], v[96:99], v[148:163]
    ds_read_b64_tr_b16 v[80:81], v7 offset:8192
    ds_read_b64_tr_b16 v[82:83], v7 offset:9216
    buffer_load_dwordx4 v[32:35], v24, s[16:19], s28 offen offset:1024 sc1
    s_waitcnt vmcnt(9) lgkmcnt(6)
    v_mfma_f32_32x32x16_bf16 v[100:115], v[36:39], v[68:71], v[100:115]
    ds_read_b64_tr_b16 v[84:85], v4 offset:12288
    ds_read_b64_tr_b16 v[86:87], v4 offset:13312
    s_waitcnt lgkmcnt(6)
    v_mfma_f32_32x32x16_bf16 v[116:131], v[36:39], v[72:75], v[116:131]
    ds_read_b64_tr_b16 v[88:89], v5 offset:12288
    ds_read_b64_tr_b16 v[90:91], v5 offset:13312
    s_waitcnt lgkmcnt(6)
    v_mfma_f32_32x32x16_bf16 v[132:147], v[36:39], v[76:79], v[132:147]
    ds_read_b64_tr_b16 v[92:93], v6 offset:12288
    ds_read_b64_tr_b16 v[94:95], v6 offset:13312
    s_waitcnt lgkmcnt(6)
    v_mfma_f32_32x32x16_bf16 v[148:163], v[36:39], v[80:83], v[148:163]
    ds_read_b64_tr_b16 v[96:97], v7 offset:12288
    ds_read_b64_tr_b16 v[98:99], v7 offset:13312
    buffer_load_dwordx4 v[36:39], v24, s[16:19], s28 offen offset:2048 sc1
    s_waitcnt vmcnt(9) lgkmcnt(6)
    v_mfma_f32_32x32x16_bf16 v[100:115], v[40:43], v[84:87], v[100:115]
    ds_read_b64_tr_b16 v[68:69], v4 offset:16384
    ds_read_b64_tr_b16 v[70:71], v4 offset:17408
    s_waitcnt lgkmcnt(6)
    v_mfma_f32_32x32x16_bf16 v[116:131], v[40:43], v[88:91], v[116:131]
    ds_read_b64_tr_b16 v[72:73], v5 offset:16384
    ds_read_b64_tr_b16 v[74:75], v5 offset:17408
    s_waitcnt lgkmcnt(6)
    v_mfma_f32_32x32x16_bf16 v[132:147], v[40:43], v[92:95], v[132:147]
    ds_read_b64_tr_b16 v[76:77], v6 offset:16384
    ds_read_b64_tr_b16 v[78:79], v6 offset:17408
    s_waitcnt lgkmcnt(6)
    v_mfma_f32_32x32x16_bf16 v[148:163], v[40:43], v[96:99], v[148:163]
    ds_read_b64_tr_b16 v[80:81], v7 offset:16384
    ds_read_b64_tr_b16 v[82:83], v7 offset:17408
    buffer_load_dwordx4 v[40:43], v24, s[16:19], s28 offen offset:3072 sc1
    s_waitcnt vmcnt(9) lgkmcnt(6)
    v_mfma_f32_32x32x16_bf16 v[100:115], v[44:47], v[68:71], v[100:115]
    ds_read_b64_tr_b16 v[84:85], v4 offset:20480
    ds_read_b64_tr_b16 v[86:87], v4 offset:21504
    s_waitcnt lgkmcnt(6)
    v_mfma_f32_32x32x16_bf16 v[116:131], v[44:47], v[72:75], v[116:131]
    ds_read_b64_tr_b16 v[88:89], v5 offset:20480
    ds_read_b64_tr_b16 v[90:91], v5 offset:21504
    s_waitcnt lgkmcnt(6)
    v_mfma_f32_32x32x16_bf16 v[132:147], v[44:47], v[76:79], v[132:147]
    ds_read_b64_tr_b16 v[92:93], v6 offset:20480
    ds_read_b64_tr_b16 v[94:95], v6 offset:21504
    s_waitcnt lgkmcnt(6)
    v_mfma_f32_32x32x16_bf16 v[148:163], v[44:47], v[80:83], v[148:163]
    ds_read_b64_tr_b16 v[96:97], v7 offset:20480
    ds_read_b64_tr_b16 v[98:99], v7 offset:21504
    s_add_u32 s28, s39, 4096
    buffer_load_dwordx4 v[44:47], v24, s[16:19], s28 offen offset:0 sc1
    s_waitcnt vmcnt(9) lgkmcnt(6)
    v_mfma_f32_32x32x16_bf16 v[100:115], v[48:51], v[84:87], v[100:115]
    ds_read_b64_tr_b16 v[68:69], v4 offset:24576
    ds_read_b64_tr_b16 v[70:71], v4 offset:25600
    s_waitcnt lgkmcnt(6)
    v_mfma_f32_32x32x16_bf16 v[116:131], v[48:51], v[88:91], v[116:131]
    ds_read_b64_tr_b16 v[72:73], v5 offset:24576
    ds_read_b64_tr_b16 v[74:75], v5 offset:25600
    s_waitcnt lgkmcnt(6)
    v_mfma_f32_32x32x16_bf16 v[132:147], v[48:51], v[92:95], v[132:147]
    ds_read_b64_tr_b16 v[76:77], v6 offset:24576
    ds_read_b64_tr_b16 v[78:79], v6 offset:25600
    s_waitcnt lgkmcnt(6)
    v_mfma_f32_32x32x16_bf16 v[148:163], v[48:51], v[96:99], v[148:163]
    ds_read_b64_tr_b16 v[80:81], v7 offset:24576
    ds_read_b64_tr_b16 v[82:83], v7 offset:25600
    buffer_load_dwordx4 v[48:51], v24, s[16:19], s28 offen offset:1024 sc1
    s_waitcnt vmcnt(9) lgkmcnt(6)
    v_mfma_f32_32x32x16_bf16 v[100:115], v[52:55], v[68:71], v[100:115]
    ds_read_b64_tr_b16 v[84:85], v4 offset:28672
    ds_read_b64_tr_b16 v[86:87], v4 offset:29696
    s_waitcnt lgkmcnt(6)
    v_mfma_f32_32x32x16_bf16 v[116:131], v[52:55], v[72:75], v[116:131]
    ds_read_b64_tr_b16 v[88:89], v5 offset:28672
    ds_read_b64_tr_b16 v[90:91], v5 offset:29696
    s_waitcnt lgkmcnt(6)
    v_mfma_f32_32x32x16_bf16 v[132:147], v[52:55], v[76:79], v[132:147]
    ds_read_b64_tr_b16 v[92:93], v6 offset:28672
    ds_read_b64_tr_b16 v[94:95], v6 offset:29696
    s_waitcnt lgkmcnt(6)
    v_mfma_f32_32x32x16_bf16 v[148:163], v[52:55], v[80:83], v[148:163]
    ds_read_b64_tr_b16 v[96:97], v7 offset:28672
    ds_read_b64_tr_b16 v[98:99], v7 offset:29696
    buffer_load_dwordx4 v[52:55], v24, s[16:19], s28 offen offset:2048 sc1
    s_waitcnt vmcnt(9) lgkmcnt(6)
    v_mfma_f32_32x32x16_bf16 v[100:115], v[56:59], v[84:87], v[100:115]
    ds_read_b64_tr_b16 v[68:69], v4 offset:32768
    ds_read_b64_tr_b16 v[70:71], v4 offset:33792
    s_waitcnt lgkmcnt(6)
    v_mfma_f32_32x32x16_bf16 v[116:131], v[56:59], v[88:91], v[116:131]
    ds_read_b64_tr_b16 v[72:73], v5 offset:32768
    ds_read_b64_tr_b16 v[74:75], v5 offset:33792
    s_waitcnt lgkmcnt(6)
    v_mfma_f32_32x32x16_bf16 v[132:147], v[56:59], v[92:95], v[132:147]
    ds_read_b64_tr_b16 v[76:77], v6 offset:32768
    ds_read_b64_tr_b16 v[78:79], v6 offset:33792
    s_waitcnt lgkmcnt(6)
    v_mfma_f32_32x32x16_bf16 v[148:163], v[56:59], v[96:99], v[148:163]
    ds_read_b64_tr_b16 v[80:81], v7 offset:32768
    ds_read_b64_tr_b16 v[82:83], v7 offset:33792
    buffer_load_dwordx4 v[56:59], v24, s[16:19], s28 offen offset:3072 sc1
    s_waitcnt vmcnt(9) lgkmcnt(6)
    v_mfma_f32_32x32x16_bf16 v[100:115], v[60:63], v[68:71], v[100:115]
    ds_read_b64_tr_b16 v[84:85], v4 offset:36864
    ds_read_b64_tr_b16 v[86:87], v4 offset:37888
    s_waitcnt lgkmcnt(6)
    v_mfma_f32_32x32x16_bf16 v[116:131], v[60:63], v[72:75], v[116:131]
    ds_read_b64_tr_b16 v[88:89], v5 offset:36864
    ds_read_b64_tr_b16 v[90:91], v5 offset:37888
    s_waitcnt lgkmcnt(6)
    v_mfma_f32_32x32x16_bf16 v[132:147], v[60:63], v[76:79], v[132:147]
    ds_read_b64_tr_b16 v[92:93], v6 offset:36864
    ds_read_b64_tr_b16 v[94:95], v6 offset:37888
    s_waitcnt lgkmcnt(6)
    v_mfma_f32_32x32x16_bf16 v[148:163], v[60:63], v[80:83], v[148:163]
    ds_read_b64_tr_b16 v[96:97], v7 offset:36864
    ds_read_b64_tr_b16 v[98:99], v7 offset:37888
    s_add_u32 s28, s39, 8192
    buffer_load_dwordx4 v[60:63], v24, s[16:19], s28 offen offset:0 sc1
    s_waitcnt vmcnt(9) lgkmcnt(6)
    v_mfma_f32_32x32x16_bf16 v[100:115], v[64:67], v[84:87], v[100:115]
    ds_read_b64_tr_b16 v[68:69], v4 offset:40960
    ds_read_b64_tr_b16 v[70:71], v4 offset:41984
    s_waitcnt lgkmcnt(6)
    v_mfma_f32_32x32x16_bf16 v[116:131], v[64:67], v[88:91], v[116:131]
    ds_read_b64_tr_b16 v[72:73], v5 offset:40960
    ds_read_b64_tr_b16 v[74:75], v5 offset:41984
    s_waitcnt lgkmcnt(6)
    v_mfma_f32_32x32x16_bf16 v[132:147], v[64:67], v[92:95], v[132:147]
    ds_read_b64_tr_b16 v[76:77], v6 offset:40960
    ds_read_b64_tr_b16 v[78:79], v6 offset:41984
    s_waitcnt lgkmcnt(6)
    v_mfma_f32_32x32x16_bf16 v[148:163], v[64:67], v[96:99], v[148:163]
    ds_read_b64_tr_b16 v[80:81], v7 offset:40960
    ds_read_b64_tr_b16 v[82:83], v7 offset:41984
    buffer_load_dwordx4 v[64:67], v24, s[16:19], s28 offen offset:1024 sc1
    v_add_u32 v4, 40960, v4
    v_add_u32 v5, 40960, v5
    v_add_u32 v6, 40960, v6
    v_add_u32 v7, 40960, v7
    s_add_u32 s39, s39, 10240
    s_add_u32 s37, s37, 1
    s_bitcmp1_b32 s37, 0
    s_cbranch_scc0 opq_qnb_v
    s_barrier
opq_qnb_v:
    s_cmp_lt_u32 s37, 4
    s_cbranch_scc1 opq_qloop_v
    s_waitcnt vmcnt(0) lgkmcnt(0)
    ds_read_b32 v26, v164 offset:512
    ds_read_b64 v[40:41], v27 offset:1024
    ds_read_b64 v[42:43], v27 offset:1280
    ds_read_b64 v[44:45], v27 offset:1536
    ds_read_b64 v[46:47], v27 offset:1792
    ds_read_b128 v[48:51], v165 offset:0
    ds_read_b128 v[52:55], v165 offset:32
    ds_read_b128 v[56:59], v165 offset:64
    ds_read_b128 v[60:63], v165 offset:96
    s_waitcnt lgkmcnt(8)
    v_mov_b32 v34, 0
    v_cndmask_b32 v34, v34, v26, s[50:51]
    v_lshrrev_b32 v37, 16, v34
    v_or_b32 v36, v37, v34
    s_waitcnt lgkmcnt(4)
    s_nop 0
    v_mfma_f32_32x32x8_bf16 v[100:115], v[36:37], v[40:41], v[100:115]
    v_mfma_f32_32x32x8_bf16 v[116:131], v[36:37], v[42:43], v[116:131]
    v_mfma_f32_32x32x8_bf16 v[132:147], v[36:37], v[44:45], v[132:147]
    v_mfma_f32_32x32x8_bf16 v[148:163], v[36:37], v[46:47], v[148:163]
    s_waitcnt lgkmcnt(0)
    s_nop 7
    v_mul_f32 v68, v48, v100
    v_mul_f32 v69, v49, v101
    v_mul_f32 v70, v50, v102
    v_mul_f32 v71, v51, v103
    v_mul_f32 v72, v52, v104
    v_mul_f32 v73, v53, v105
    v_mul_f32 v74, v54, v106
    v_mul_f32 v75, v55, v107
    v_cvt_pk_bf16_f32 v76, v68, v69
    v_cvt_pk_bf16_f32 v77, v70, v71
    v_cvt_pk_bf16_f32 v78, v72, v73
    v_cvt_pk_bf16_f32 v79, v74, v75
    buffer_store_dwordx4 v[76:79], v8, s[24:27], s40 offen offset:0 sc0 sc1
    v_mul_f32 v84, v56, v108
    v_mul_f32 v85, v57, v109
    v_mul_f32 v86, v58, v110
    v_mul_f32 v87, v59, v111
    v_mul_f32 v88, v60, v112
    v_mul_f32 v89, v61, v113
    v_mul_f32 v90, v62, v114
    v_mul_f32 v91, v63, v115
    v_cvt_pk_bf16_f32 v92, v84, v85
    v_cvt_pk_bf16_f32 v93, v86, v87
    v_cvt_pk_bf16_f32 v94, v88, v89
    v_cvt_pk_bf16_f32 v95, v90, v91
    buffer_store_dwordx4 v[92:95], v8, s[24:27], s40 offen offset:640 sc0 sc1
    v_mul_f32 v68, v48, v116
    v_mul_f32 v69, v49, v117
    v_mul_f32 v70, v50, v118
    v_mul_f32 v71, v51, v119
    v_mul_f32 v72, v52, v120
    v_mul_f32 v73, v53, v121
    v_mul_f32 v74, v54, v122
    v_mul_f32 v75, v55, v123
    v_cvt_pk_bf16_f32 v76, v68, v69
    v_cvt_pk_bf16_f32 v77, v70, v71
    v_cvt_pk_bf16_f32 v78, v72, v73
    v_cvt_pk_bf16_f32 v79, v74, v75
    buffer_store_dwordx4 v[76:79], v9, s[24:27], s40 offen offset:0 sc0 sc1
    v_mul_f32 v84, v56, v124
    v_mul_f32 v85, v57, v125
    v_mul_f32 v86, v58, v126
    v_mul_f32 v87, v59, v127
    v_mul_f32 v88, v60, v128
    v_mul_f32 v89, v61, v129
    v_mul_f32 v90, v62, v130
    v_mul_f32 v91, v63, v131
    v_cvt_pk_bf16_f32 v92, v84, v85
    v_cvt_pk_bf16_f32 v93, v86, v87
    v_cvt_pk_bf16_f32 v94, v88, v89
    v_cvt_pk_bf16_f32 v95, v90, v91
    buffer_store_dwordx4 v[92:95], v9, s[24:27], s40 offen offset:640 sc0 sc1
    v_mul_f32 v68, v48, v132
    v_mul_f32 v69, v49, v133
    v_mul_f32 v70, v50, v134
    v_mul_f32 v71, v51, v135
    v_mul_f32 v72, v52, v136
    v_mul_f32 v73, v53, v137
    v_mul_f32 v74, v54, v138
    v_mul_f32 v75, v55, v139
    v_cvt_pk_bf16_f32 v76, v68, v69
    v_cvt_pk_bf16_f32 v77, v70, v71
    v_cvt_pk_bf16_f32 v78, v72, v73
    v_cvt_pk_bf16_f32 v79, v74, v75
    buffer_store_dwordx4 v[76:79], v10, s[24:27], s40 offen offset:0 sc0 sc1
    v_mul_f32 v84, v56, v140
    v_mul_f32 v85, v57, v141
    v_mul_f32 v86, v58, v142
    v_mul_f32 v87, v59, v143
    v_mul_f32 v88, v60, v144
    v_mul_f32 v89, v61, v145
    v_mul_f32 v90, v62, v146
    v_mul_f32 v91, v63, v147
    v_cvt_pk_bf16_f32 v92, v84, v85
    v_cvt_pk_bf16_f32 v93, v86, v87
    v_cvt_pk_bf16_f32 v94, v88, v89
    v_cvt_pk_bf16_f32 v95, v90, v91
    buffer_store_dwordx4 v[92:95], v10, s[24:27], s40 offen offset:640 sc0 sc1
    v_mul_f32 v68, v48, v148
    v_mul_f32 v69, v49, v149
    v_mul_f32 v70, v50, v150
    v_mul_f32 v71, v51, v151
    v_mul_f32 v72, v52, v152
    v_mul_f32 v73, v53, v153
    v_mul_f32 v74, v54, v154
    v_mul_f32 v75, v55, v155
    v_cvt_pk_bf16_f32 v76, v68, v69
    v_cvt_pk_bf16_f32 v77, v70, v71
    v_cvt_pk_bf16_f32 v78, v72, v73
    v_cvt_pk_bf16_f32 v79, v74, v75
    buffer_store_dwordx4 v[76:79], v11, s[24:27], s40 offen offset:0 sc0 sc1
    v_mul_f32 v84, v56, v156
    v_mul_f32 v85, v57, v157
    v_mul_f32 v86, v58, v158
    v_mul_f32 v87, v59, v159
    v_mul_f32 v88, v60, v160
    v_mul_f32 v89, v61, v161
    v_mul_f32 v90, v62, v162
    v_mul_f32 v91, v63, v163
    v_cvt_pk_bf16_f32 v92, v84, v85
    v_cvt_pk_bf16_f32 v93, v86, v87
    v_cvt_pk_bf16_f32 v94, v88, v89
    v_cvt_pk_bf16_f32 v95, v90, v91
    buffer_store_dwordx4 v[92:95], v11, s[24:27], s40 offen offset:640 sc0 sc1
    s_branch opq_fin
.section .rodata,"a"
.p2align 6
.amdhsa_kernel qkv0_kernel
  .amdhsa_next_free_vgpr 192
  .amdhsa_next_free_sgpr 96
  .amdhsa_accum_offset 192
  .amdhsa_group_segment_fixed_size 0
  .amdhsa_kernarg_size 72
  .amdhsa_user_sgpr_count 2
  .amdhsa_user_sgpr_kernarg_segment_ptr 1
  .amdhsa_system_sgpr_workgroup_id_x 1
.end_amdhsa_kernel
.p2align 6
.amdhsa_kernel fus0_kernel
  .amdhsa_next_free_vgpr 168
  .amdhsa_next_free_sgpr 96
  .amdhsa_accum_offset 168
  .amdhsa_group_segment_fixed_size 0
  .amdhsa_kernarg_size 72
  .amdhsa_user_sgpr_count 2
  .amdhsa_user_sgpr_kernarg_segment_ptr 1
  .amdhsa_system_sgpr_workgroup_id_x 1
.end_amdhsa_kernel
.p2align 6
.amdhsa_kernel fus1_kernel
  .amdhsa_next_free_vgpr 168
  .amdhsa_next_free_sgpr 96
  .amdhsa_accum_offset 168
  .amdhsa_group_segment_fixed_size 0
  .amdhsa_kernarg_size 72
  .amdhsa_user_sgpr_count 2
  .amdhsa_user_sgpr_kernarg_segment_ptr 1
  .amdhsa_system_sgpr_workgroup_id_x 1
.end_amdhsa_kernel
.p2align 6
.amdhsa_kernel fus2_kernel
  .amdhsa_next_free_vgpr 168
  .amdhsa_next_free_sgpr 96
  .amdhsa_accum_offset 168
  .amdhsa_group_segment_fixed_size 0
  .amdhsa_kernarg_size 72
  .amdhsa_user_sgpr_count 2
  .amdhsa_user_sgpr_kernarg_segment_ptr 1
  .amdhsa_system_sgpr_workgroup_id_x 1
.end_amdhsa_kernel
.p2align 6
.amdhsa_kernel fus3_kernel
  .amdhsa_next_free_vgpr 168
  .amdhsa_next_free_sgpr 96
  .amdhsa_accum_offset 168
  .amdhsa_group_segment_fixed_size 0
  .amdhsa_kernarg_size 72
  .amdhsa_user_sgpr_count 2
  .amdhsa_user_sgpr_kernarg_segment_ptr 1
  .amdhsa_system_sgpr_workgroup_id_x 1
.end_amdhsa_kernel
```
